```python
import torch

def _softmax(x, axis=-1):
    return torch.softmax(x, dim=axis)
def _gelu(x):
    return torch.nn.functional.gelu(x, approximate="tanh")
def _silu(x):
    return torch.nn.functional.silu(x)
def _sigmoid(x):
    return torch.sigmoid(x)
def _layernorm(x, axis=-1, eps=1e-5):
    m = x.mean(dim=axis, keepdim=True)
    v = x.var(dim=axis, keepdim=True, unbiased=False)
    return (x - m) / torch.sqrt(v + eps)
def _scatter_add(tgt, idx, src, axis=0):
    return tgt.clone().index_add_(axis, idx, src)
def _segment_sum(src, seg, n):
    out = torch.zeros((n,) + src.shape[1:], dtype=src.dtype)
    return out.index_add_(0, seg, src)
def _pad(x, pw):
    flat = tuple(v for pair in reversed(pw) for v in pair)
    return torch.nn.functional.pad(x, flat)

kernel_name = 'recurrent_scan__spectral_fnet__glu_gated_glu__prompt'

def setup_inputs():

    _w = (lambda a: (lambda t: t.to(torch.bfloat16) if t.is_floating_point() else t)(torch.as_tensor(a)))
    def _A_setup():
        B, S, D = 1, 2048, 576
        ns = torch.arange(S)[:, None] * torch.arange(S)[None, :]
        nd = torch.arange(D)[:, None] * torch.arange(D)[None, :]
        Ws_re = torch.cos(-2.0 * torch.pi * ns / S).to(float)
        Ws_im = torch.sin(-2.0 * torch.pi * ns / S).to(float)
        Wd_re = torch.cos(-2.0 * torch.pi * nd / D).to(float)
        Wd_im = torch.sin(-2.0 * torch.pi * nd / D).to(float)
        return {
            "x": _w((lambda *s: torch.randn(*s, dtype=torch.bfloat16) * 0.05)(B, S, D)),
            "dft_seq_re": _w(Ws_re),
            "dft_seq_im": _w(Ws_im),
            "dft_hid_re": _w(Wd_re),
            "dft_hid_im": _w(Wd_im),
        }
    _A_in = _A_setup()

    def _B_setup():
        B, S, D, F = 1, 2048, 576, 4608
        return {
            "x": _w((lambda *s: torch.randn(*s, dtype=torch.bfloat16) * 0.05)(B, S, D)),
            "w_gate": _w((lambda *s: torch.randn(*s, dtype=torch.bfloat16) * 0.05)(D, F)),
            "w_up": _w((lambda *s: torch.randn(*s, dtype=torch.bfloat16) * 0.05)(D, F)),
            "w_down": _w((lambda *s: torch.randn(*s, dtype=torch.bfloat16) * 0.05)(F, D)),
        }
    _B_in = _B_setup()

    return {
        "A_x": _A_in["x"],
        "A_dft_seq_re": _A_in["dft_seq_re"],
        "A_dft_seq_im": _A_in["dft_seq_im"],
        "A_dft_hid_re": _A_in["dft_hid_re"],
        "A_dft_hid_im": _A_in["dft_hid_im"],
        "B_x": _B_in["x"],
        "B_w_gate": _B_in["w_gate"],
        "B_w_up": _B_in["w_up"],
        "B_w_down": _B_in["w_down"],
    }

def reference(A_x, A_dft_seq_re, A_dft_seq_im, A_dft_hid_re, A_dft_hid_im, B_x, B_w_gate, B_w_up, B_w_down):
    def _A_ref(x, dft_seq_re, dft_seq_im, dft_hid_re, dft_hid_im):
        a = torch.einsum("bsd,ed->bse", x, dft_hid_re)
        b = torch.einsum("bsd,ed->bse", x, dft_hid_im)
        y = torch.einsum("ts,bse->bte", dft_seq_re, a) - torch.einsum("ts,bse->bte", dft_seq_im, b)
        return y

    def _B_ref(x, w_gate, w_up, w_down):
        g = torch.einsum("bsd,df->bsf", x, w_gate)
        u = torch.einsum("bsd,df->bsf", x, w_up)
        h = _sigmoid(g) * u
        return torch.einsum("bsf,fd->bsd", h, w_down)

    x = A_x
    xn = _layernorm(x, axis=-1)
    s = _A_ref(xn, A_dft_seq_re, A_dft_seq_im, A_dft_hid_re, A_dft_hid_im)
    g = _silu(_B_ref(xn, B_w_gate, B_w_up, B_w_down))
    return x + s * g
```

```asm
; @launch kernel=ln_kernel grid=(512,1,1) block=(256,1,1) lds=0
; @launch kernel=gemm1_kernel grid=(1296,1,1) block=(256,1,1) lds=65536
; @launch kernel=gemm2_kernel grid=(240,1,1) block=(256,1,1) lds=163840
; @launch kernel=final_kernel grid=(1152,1,1) block=(256,1,1) lds=0
.amdgcn_target "amdgcn-amd-amdhsa--gfx950"
.text
.globl ln_kernel
.p2align 8
.type ln_kernel,@function
ln_kernel:
    s_cmp_ge_u32 s2, 512
    s_cbranch_scc1 ln_done
    s_load_dwordx2 s[4:5], s[0:1], 0
    s_load_dwordx2 s[6:7], s[0:1], 88
    v_lshrrev_b32 v1, 6, v0
    v_and_b32 v2, 63, v0
    s_lshl_b32 s3, s2, 2
    v_add_u32 v1, s3, v1
    s_movk_i32 s3, 1152
    v_mul_lo_u32 v3, s3, v1
    v_lshl_add_u32 v3, v2, 2, v3
    s_waitcnt lgkmcnt(0)
    s_mov_b32 s8, s4
    s_mov_b32 s9, s5
    s_and_b32 s9, s9, 0xffff
    s_mov_b32 s10, 0x240000
    s_mov_b32 s11, 0x00020000
    s_mov_b32 s12, s6
    s_mov_b32 s13, s7
    s_and_b32 s13, s13, 0xffff
    s_mov_b32 s14, 0x240000
    s_mov_b32 s15, 0x00020000
    v_mov_b32 v14, 0
    buffer_load_dword v10, v3, s[8:11], 0 offen offset:0
    buffer_load_dword v11, v3, s[8:11], 0 offen offset:256
    buffer_load_dword v12, v3, s[8:11], 0 offen offset:512
    buffer_load_dword v13, v3, s[8:11], 0 offen offset:768
    v_cmp_gt_u32 vcc, 32, v2
    s_and_saveexec_b64 s[16:17], vcc
    buffer_load_dword v14, v3, s[8:11], 0 offen offset:1024
    s_mov_b64 exec, s[16:17]
    s_waitcnt vmcnt(0)
    v_lshlrev_b32 v20, 16, v10
    v_and_b32 v21, 0xffff0000, v10
    v_lshlrev_b32 v22, 16, v11
    v_and_b32 v23, 0xffff0000, v11
    v_lshlrev_b32 v24, 16, v12
    v_and_b32 v25, 0xffff0000, v12
    v_lshlrev_b32 v26, 16, v13
    v_and_b32 v27, 0xffff0000, v13
    v_lshlrev_b32 v28, 16, v14
    v_and_b32 v29, 0xffff0000, v14
    v_add_f32 v30, v20, v21
    v_add_f32 v30, v30, v22
    v_add_f32 v30, v30, v23
    v_add_f32 v30, v30, v24
    v_add_f32 v30, v30, v25
    v_add_f32 v30, v30, v26
    v_add_f32 v30, v30, v27
    v_add_f32 v30, v30, v28
    v_add_f32 v30, v30, v29
    ds_swizzle_b32 v31, v30 offset:0x41f
    s_waitcnt lgkmcnt(0)
    v_add_f32 v30, v30, v31
    ds_swizzle_b32 v31, v30 offset:0x81f
    s_waitcnt lgkmcnt(0)
    v_add_f32 v30, v30, v31
    ds_swizzle_b32 v31, v30 offset:0x101f
    s_waitcnt lgkmcnt(0)
    v_add_f32 v30, v30, v31
    ds_swizzle_b32 v31, v30 offset:0x201f
    s_waitcnt lgkmcnt(0)
    v_add_f32 v30, v30, v31
    ds_swizzle_b32 v31, v30 offset:0x401f
    s_waitcnt lgkmcnt(0)
    v_add_f32 v30, v30, v31
    s_nop 0
    v_readlane_b32 s18, v30, 0
    v_readlane_b32 s19, v30, 32
    s_nop 1
    v_mov_b32 v30, s18
    v_add_f32 v30, s19, v30
    v_mul_f32 v30, 0x3ae38e39, v30
    v_cmp_gt_u32 vcc, 32, v2
    v_sub_f32 v40, v20, v30
    v_sub_f32 v41, v21, v30
    v_sub_f32 v42, v22, v30
    v_sub_f32 v43, v23, v30
    v_sub_f32 v44, v24, v30
    v_sub_f32 v45, v25, v30
    v_sub_f32 v46, v26, v30
    v_sub_f32 v47, v27, v30
    v_sub_f32 v48, v28, v30
    v_sub_f32 v49, v29, v30
    v_cndmask_b32 v48, 0, v48, vcc
    v_cndmask_b32 v49, 0, v49, vcc
    v_mul_f32 v32, v40, v40
    v_fmac_f32 v32, v41, v41
    v_fmac_f32 v32, v42, v42
    v_fmac_f32 v32, v43, v43
    v_fmac_f32 v32, v44, v44
    v_fmac_f32 v32, v45, v45
    v_fmac_f32 v32, v46, v46
    v_fmac_f32 v32, v47, v47
    v_fmac_f32 v32, v48, v48
    v_fmac_f32 v32, v49, v49
    ds_swizzle_b32 v31, v32 offset:0x41f
    s_waitcnt lgkmcnt(0)
    v_add_f32 v32, v32, v31
    ds_swizzle_b32 v31, v32 offset:0x81f
    s_waitcnt lgkmcnt(0)
    v_add_f32 v32, v32, v31
    ds_swizzle_b32 v31, v32 offset:0x101f
    s_waitcnt lgkmcnt(0)
    v_add_f32 v32, v32, v31
    ds_swizzle_b32 v31, v32 offset:0x201f
    s_waitcnt lgkmcnt(0)
    v_add_f32 v32, v32, v31
    ds_swizzle_b32 v31, v32 offset:0x401f
    s_waitcnt lgkmcnt(0)
    v_add_f32 v32, v32, v31
    s_nop 0
    v_readlane_b32 s18, v32, 0
    v_readlane_b32 s19, v32, 32
    s_nop 1
    v_mov_b32 v32, s18
    v_add_f32 v32, s19, v32
    v_mul_f32 v32, 0x3ae38e39, v32
    v_cvt_pk_bf16_f32 v33, v30, v32
    v_lshlrev_b32 v34, 16, v33
    v_and_b32 v35, 0xffff0000, v33
    v_add_f32 v35, 0x3727c5ac, v35
    v_cvt_pk_bf16_f32 v35, v35, v35
    v_lshlrev_b32 v35, 16, v35
    v_sqrt_f32 v35, v35
    s_nop 0
    v_cvt_pk_bf16_f32 v35, v35, v35
    v_lshlrev_b32 v35, 16, v35
    v_rcp_f32 v36, v35
    v_sub_f32 v40, v20, v34
    v_sub_f32 v41, v21, v34
    v_sub_f32 v42, v22, v34
    v_sub_f32 v43, v23, v34
    v_sub_f32 v44, v24, v34
    v_sub_f32 v45, v25, v34
    v_sub_f32 v46, v26, v34
    v_sub_f32 v47, v27, v34
    v_sub_f32 v48, v28, v34
    v_sub_f32 v49, v29, v34
    v_cvt_pk_bf16_f32 v50, v40, v41
    v_cvt_pk_bf16_f32 v51, v42, v43
    v_cvt_pk_bf16_f32 v52, v44, v45
    v_cvt_pk_bf16_f32 v53, v46, v47
    v_cvt_pk_bf16_f32 v54, v48, v49
    v_lshlrev_b32 v40, 16, v50
    v_and_b32 v41, 0xffff0000, v50
    v_lshlrev_b32 v42, 16, v51
    v_and_b32 v43, 0xffff0000, v51
    v_lshlrev_b32 v44, 16, v52
    v_and_b32 v45, 0xffff0000, v52
    v_lshlrev_b32 v46, 16, v53
    v_and_b32 v47, 0xffff0000, v53
    v_lshlrev_b32 v48, 16, v54
    v_and_b32 v49, 0xffff0000, v54
    v_mul_f32 v60, v40, v36
    v_mul_f32 v61, v41, v36
    v_mul_f32 v62, v42, v36
    v_mul_f32 v63, v43, v36
    v_mul_f32 v64, v44, v36
    v_mul_f32 v65, v45, v36
    v_mul_f32 v66, v46, v36
    v_mul_f32 v67, v47, v36
    v_mul_f32 v68, v48, v36
    v_mul_f32 v69, v49, v36
    v_fma_f32 v70, -v60, v35, v40
    v_fma_f32 v71, -v61, v35, v41
    v_fma_f32 v72, -v62, v35, v42
    v_fma_f32 v73, -v63, v35, v43
    v_fma_f32 v74, -v64, v35, v44
    v_fma_f32 v75, -v65, v35, v45
    v_fma_f32 v76, -v66, v35, v46
    v_fma_f32 v77, -v67, v35, v47
    v_fma_f32 v78, -v68, v35, v48
    v_fma_f32 v79, -v69, v35, v49
    v_fmac_f32 v60, v70, v36
    v_fmac_f32 v61, v71, v36
    v_fmac_f32 v62, v72, v36
    v_fmac_f32 v63, v73, v36
    v_fmac_f32 v64, v74, v36
    v_fmac_f32 v65, v75, v36
    v_fmac_f32 v66, v76, v36
    v_fmac_f32 v67, v77, v36
    v_fmac_f32 v68, v78, v36
    v_fmac_f32 v69, v79, v36
    v_cvt_pk_bf16_f32 v50, v60, v61
    v_cvt_pk_bf16_f32 v51, v62, v63
    v_cvt_pk_bf16_f32 v52, v64, v65
    v_cvt_pk_bf16_f32 v53, v66, v67
    v_cvt_pk_bf16_f32 v54, v68, v69
    buffer_store_dword v50, v3, s[12:15], 0 offen offset:0
    buffer_store_dword v51, v3, s[12:15], 0 offen offset:256
    buffer_store_dword v52, v3, s[12:15], 0 offen offset:512
    buffer_store_dword v53, v3, s[12:15], 0 offen offset:768
    v_cmp_gt_u32 vcc, 32, v2
    s_and_saveexec_b64 s[16:17], vcc
    buffer_store_dword v54, v3, s[12:15], 0 offen offset:1024
    s_mov_b64 exec, s[16:17]
    s_waitcnt vmcnt(0)
ln_done:
    s_endpgm
.globl gemm1_kernel
.p2align 8
.type gemm1_kernel,@function
gemm1_kernel:
    s_cmp_ge_u32 s2, 1296
    s_cbranch_scc1 k1_done
    s_load_dwordx2 s[4:5], s[0:1], 88
    s_load_dwordx4 s[40:43], s[0:1], 24
    s_load_dwordx4 s[44:47], s[0:1], 48
    v_lshrrev_b32 v1, 6, v0
    v_and_b32 v10, 63, v0
    v_readfirstlane_b32 s32, v1
    v_and_b32 v1, 15, v10
    v_lshlrev_b32 v1, 7, v1
    v_lshrrev_b32 v2, 4, v10
    v_and_b32 v3, 7, v10
    v_xor_b32 v2, v2, v3
    v_lshl_add_u32 v9, v2, 4, v1
    s_lshr_b32 s34, s32, 1
    s_lshl_b32 s34, s34, 13
    v_add_u32 v14, s34, v9
    v_xor_b32 v15, 64, v14
    s_lshl_b32 s30, s32, 12
    s_waitcnt lgkmcnt(0)
    s_mov_b32 s8, s4
    s_mov_b32 s9, s5
    s_and_b32 s9, s9, 0xffff
    s_mov_b32 s10, 0x240000
    s_mov_b32 s11, 0x00020000
    s_cmp_ge_u32 s2, 144
    s_cbranch_scc1 k1_gu
    s_and_b32 s36, s2, 15
    s_lshl_b32 s36, s36, 7
    s_lshr_b32 s37, s2, 4
    s_lshl_b32 s37, s37, 6
    s_cmp_ge_u32 s32, 2
    s_cselect_b32 s6, s42, s40
    s_cselect_b32 s7, s43, s41
    s_mov_b32 s12, s6
    s_mov_b32 s13, s7
    s_and_b32 s13, s13, 0xffff
    s_mov_b32 s14, 0xa2000
    s_mov_b32 s15, 0x00020000
    v_lshrrev_b32 v1, 3, v10
    v_and_b32 v2, 7, v10
    v_xor_b32 v2, v2, v1
    v_lshlrev_b32 v2, 4, v2
    s_lshl_b32 s34, s32, 5
    v_add_u32 v3, s34, v1
    s_mov_b32 s34, 1152
    v_mul_lo_u32 v3, s34, v3
    v_add_u32 v11, v3, v2
    s_mul_i32 s34, s36, 1152
    s_add_u32 s20, s34, 0
    s_add_u32 s21, s34, 9216
    s_add_u32 s22, s34, 18432
    s_add_u32 s23, s34, 27648
    s_and_b32 s38, s32, 1
    s_lshl_b32 s38, s38, 5
    s_add_u32 s38, s38, s37
    s_mov_b32 s34, 1152
    v_mul_lo_u32 v3, s34, v1
    v_add_u32 v12, v3, v2
    s_mul_i32 s34, s38, 1152
    s_add_u32 s24, s34, 0
    s_add_u32 s25, s34, 9216
    s_add_u32 s26, s34, 18432
    s_add_u32 s27, s34, 27648
    s_and_b32 s34, s32, 1
    s_mul_i32 s34, s34, 4096
    s_add_u32 s34, s34, 16384
    v_add_u32 v16, s34, v9
    v_xor_b32 v17, 64, v16
    s_mul_i32 s31, s32, 4096
    s_add_u32 s31, s31, 16384
    v_add_u32 v22, 0x10000, v14
    v_add_u32 v23, 0x10000, v15
    v_add_u32 v24, 0x10000, v16
    v_add_u32 v25, 0x10000, v17
    v_add_u32 v26, 0x10000, v18
    v_add_u32 v27, 0x10000, v19
    v_add_u32 v28, 0x10000, v20
    v_add_u32 v29, 0x10000, v21
    v_mov_b32 v32, 0
    v_mov_b32 v33, 0
    v_mov_b32 v34, 0
    v_mov_b32 v35, 0
    v_mov_b32 v36, 0
    v_mov_b32 v37, 0
    v_mov_b32 v38, 0
    v_mov_b32 v39, 0
    v_mov_b32 v40, 0
    v_mov_b32 v41, 0
    v_mov_b32 v42, 0
    v_mov_b32 v43, 0
    v_mov_b32 v44, 0
    v_mov_b32 v45, 0
    v_mov_b32 v46, 0
    v_mov_b32 v47, 0
    v_mov_b32 v48, 0
    v_mov_b32 v49, 0
    v_mov_b32 v50, 0
    v_mov_b32 v51, 0
    v_mov_b32 v52, 0
    v_mov_b32 v53, 0
    v_mov_b32 v54, 0
    v_mov_b32 v55, 0
    v_mov_b32 v56, 0
    v_mov_b32 v57, 0
    v_mov_b32 v58, 0
    v_mov_b32 v59, 0
    v_mov_b32 v60, 0
    v_mov_b32 v61, 0
    v_mov_b32 v62, 0
    v_mov_b32 v63, 0
    v_mov_b32 v64, 0
    v_mov_b32 v65, 0
    v_mov_b32 v66, 0
    v_mov_b32 v67, 0
    v_mov_b32 v68, 0
    v_mov_b32 v69, 0
    v_mov_b32 v70, 0
    v_mov_b32 v71, 0
    v_mov_b32 v72, 0
    v_mov_b32 v73, 0
    v_mov_b32 v74, 0
    v_mov_b32 v75, 0
    v_mov_b32 v76, 0
    v_mov_b32 v77, 0
    v_mov_b32 v78, 0
    v_mov_b32 v79, 0
    v_mov_b32 v80, 0
    v_mov_b32 v81, 0
    v_mov_b32 v82, 0
    v_mov_b32 v83, 0
    v_mov_b32 v84, 0
    v_mov_b32 v85, 0
    v_mov_b32 v86, 0
    v_mov_b32 v87, 0
    v_mov_b32 v88, 0
    v_mov_b32 v89, 0
    v_mov_b32 v90, 0
    v_mov_b32 v91, 0
    v_mov_b32 v92, 0
    v_mov_b32 v93, 0
    v_mov_b32 v94, 0
    v_mov_b32 v95, 0
    s_add_u32 m0, s30, 0
    s_nop 0
    buffer_load_dwordx4 v11, s[8:11], s20 offen lds
    s_add_u32 s20, s20, 128
    s_add_u32 m0, s30, 1024
    s_nop 0
    buffer_load_dwordx4 v11, s[8:11], s21 offen lds
    s_add_u32 s21, s21, 128
    s_add_u32 m0, s30, 2048
    s_nop 0
    buffer_load_dwordx4 v11, s[8:11], s22 offen lds
    s_add_u32 s22, s22, 128
    s_add_u32 m0, s30, 3072
    s_nop 0
    buffer_load_dwordx4 v11, s[8:11], s23 offen lds
    s_add_u32 s23, s23, 128
    s_add_u32 m0, s31, 0
    s_nop 0
    buffer_load_dwordx4 v12, s[12:15], s24 offen lds
    s_add_u32 s24, s24, 128
    s_add_u32 m0, s31, 1024
    s_nop 0
    buffer_load_dwordx4 v12, s[12:15], s25 offen lds
    s_add_u32 s25, s25, 128
    s_add_u32 m0, s31, 2048
    s_nop 0
    buffer_load_dwordx4 v12, s[12:15], s26 offen lds
    s_add_u32 s26, s26, 128
    s_add_u32 m0, s31, 3072
    s_nop 0
    buffer_load_dwordx4 v12, s[12:15], s27 offen lds
    s_add_u32 s27, s27, 128
    s_mov_b32 s33, 0
kloop_1:
    s_waitcnt vmcnt(0)
    s_barrier
    ds_read_b128 v[96:99], v14 offset:0
    ds_read_b128 v[100:103], v14 offset:2048
    ds_read_b128 v[104:107], v14 offset:4096
    ds_read_b128 v[108:111], v14 offset:6144
    ds_read_b128 v[112:115], v16 offset:0
    ds_read_b128 v[116:119], v16 offset:2048
    ds_read_b128 v[120:123], v16 offset:8192
    ds_read_b128 v[124:127], v16 offset:10240
    ds_read_b128 v[128:131], v15 offset:0
    ds_read_b128 v[132:135], v15 offset:2048
    ds_read_b128 v[136:139], v15 offset:4096
    ds_read_b128 v[140:143], v15 offset:6144
    ds_read_b128 v[144:147], v17 offset:0
    ds_read_b128 v[148:151], v17 offset:2048
    ds_read_b128 v[152:155], v17 offset:8192
    ds_read_b128 v[156:159], v17 offset:10240
    s_add_u32 m0, s30, 32768
    s_nop 0
    buffer_load_dwordx4 v11, s[8:11], s20 offen lds
    s_add_u32 s20, s20, 128
    s_add_u32 m0, s30, 33792
    s_nop 0
    buffer_load_dwordx4 v11, s[8:11], s21 offen lds
    s_add_u32 s21, s21, 128
    s_add_u32 m0, s30, 34816
    s_nop 0
    buffer_load_dwordx4 v11, s[8:11], s22 offen lds
    s_add_u32 s22, s22, 128
    s_add_u32 m0, s30, 35840
    s_nop 0
    buffer_load_dwordx4 v11, s[8:11], s23 offen lds
    s_add_u32 s23, s23, 128
    s_add_u32 m0, s31, 32768
    s_nop 0
    buffer_load_dwordx4 v12, s[12:15], s24 offen lds
    s_add_u32 s24, s24, 128
    s_add_u32 m0, s31, 33792
    s_nop 0
    buffer_load_dwordx4 v12, s[12:15], s25 offen lds
    s_add_u32 s25, s25, 128
    s_add_u32 m0, s31, 34816
    s_nop 0
    buffer_load_dwordx4 v12, s[12:15], s26 offen lds
    s_add_u32 s26, s26, 128
    s_add_u32 m0, s31, 35840
    s_nop 0
    buffer_load_dwordx4 v12, s[12:15], s27 offen lds
    s_add_u32 s27, s27, 128
    s_waitcnt lgkmcnt(8)
    v_mfma_f32_16x16x32_bf16 v[32:35], v[96:99], v[112:115], v[32:35]
    v_mfma_f32_16x16x32_bf16 v[36:39], v[96:99], v[116:119], v[36:39]
    v_mfma_f32_16x16x32_bf16 v[40:43], v[96:99], v[120:123], v[40:43]
    v_mfma_f32_16x16x32_bf16 v[44:47], v[96:99], v[124:127], v[44:47]
    v_mfma_f32_16x16x32_bf16 v[48:51], v[100:103], v[112:115], v[48:51]
    v_mfma_f32_16x16x32_bf16 v[52:55], v[100:103], v[116:119], v[52:55]
    v_mfma_f32_16x16x32_bf16 v[56:59], v[100:103], v[120:123], v[56:59]
    v_mfma_f32_16x16x32_bf16 v[60:63], v[100:103], v[124:127], v[60:63]
    v_mfma_f32_16x16x32_bf16 v[64:67], v[104:107], v[112:115], v[64:67]
    v_mfma_f32_16x16x32_bf16 v[68:71], v[104:107], v[116:119], v[68:71]
    v_mfma_f32_16x16x32_bf16 v[72:75], v[104:107], v[120:123], v[72:75]
    v_mfma_f32_16x16x32_bf16 v[76:79], v[104:107], v[124:127], v[76:79]
    v_mfma_f32_16x16x32_bf16 v[80:83], v[108:111], v[112:115], v[80:83]
    v_mfma_f32_16x16x32_bf16 v[84:87], v[108:111], v[116:119], v[84:87]
    v_mfma_f32_16x16x32_bf16 v[88:91], v[108:111], v[120:123], v[88:91]
    v_mfma_f32_16x16x32_bf16 v[92:95], v[108:111], v[124:127], v[92:95]
    s_waitcnt lgkmcnt(0)
    v_mfma_f32_16x16x32_bf16 v[32:35], v[128:131], v[144:147], v[32:35]
    v_mfma_f32_16x16x32_bf16 v[36:39], v[128:131], v[148:151], v[36:39]
    v_mfma_f32_16x16x32_bf16 v[40:43], v[128:131], v[152:155], v[40:43]
    v_mfma_f32_16x16x32_bf16 v[44:47], v[128:131], v[156:159], v[44:47]
    v_mfma_f32_16x16x32_bf16 v[48:51], v[132:135], v[144:147], v[48:51]
    v_mfma_f32_16x16x32_bf16 v[52:55], v[132:135], v[148:151], v[52:55]
    v_mfma_f32_16x16x32_bf16 v[56:59], v[132:135], v[152:155], v[56:59]
    v_mfma_f32_16x16x32_bf16 v[60:63], v[132:135], v[156:159], v[60:63]
    v_mfma_f32_16x16x32_bf16 v[64:67], v[136:139], v[144:147], v[64:67]
    v_mfma_f32_16x16x32_bf16 v[68:71], v[136:139], v[148:151], v[68:71]
    v_mfma_f32_16x16x32_bf16 v[72:75], v[136:139], v[152:155], v[72:75]
    v_mfma_f32_16x16x32_bf16 v[76:79], v[136:139], v[156:159], v[76:79]
    v_mfma_f32_16x16x32_bf16 v[80:83], v[140:143], v[144:147], v[80:83]
    v_mfma_f32_16x16x32_bf16 v[84:87], v[140:143], v[148:151], v[84:87]
    v_mfma_f32_16x16x32_bf16 v[88:91], v[140:143], v[152:155], v[88:91]
    v_mfma_f32_16x16x32_bf16 v[92:95], v[140:143], v[156:159], v[92:95]
    s_waitcnt vmcnt(0)
    s_barrier
    ds_read_b128 v[96:99], v14 offset:32768
    ds_read_b128 v[100:103], v14 offset:34816
    ds_read_b128 v[104:107], v14 offset:36864
    ds_read_b128 v[108:111], v14 offset:38912
    ds_read_b128 v[112:115], v16 offset:32768
    ds_read_b128 v[116:119], v16 offset:34816
    ds_read_b128 v[120:123], v16 offset:40960
    ds_read_b128 v[124:127], v16 offset:43008
    ds_read_b128 v[128:131], v15 offset:32768
    ds_read_b128 v[132:135], v15 offset:34816
    ds_read_b128 v[136:139], v15 offset:36864
    ds_read_b128 v[140:143], v15 offset:38912
    ds_read_b128 v[144:147], v17 offset:32768
    ds_read_b128 v[148:151], v17 offset:34816
    ds_read_b128 v[152:155], v17 offset:40960
    ds_read_b128 v[156:159], v17 offset:43008
    s_add_u32 m0, s30, 0
    s_nop 0
    buffer_load_dwordx4 v11, s[8:11], s20 offen lds
    s_add_u32 s20, s20, 128
    s_add_u32 m0, s30, 1024
    s_nop 0
    buffer_load_dwordx4 v11, s[8:11], s21 offen lds
    s_add_u32 s21, s21, 128
    s_add_u32 m0, s30, 2048
    s_nop 0
    buffer_load_dwordx4 v11, s[8:11], s22 offen lds
    s_add_u32 s22, s22, 128
    s_add_u32 m0, s30, 3072
    s_nop 0
    buffer_load_dwordx4 v11, s[8:11], s23 offen lds
    s_add_u32 s23, s23, 128
    s_add_u32 m0, s31, 0
    s_nop 0
    buffer_load_dwordx4 v12, s[12:15], s24 offen lds
    s_add_u32 s24, s24, 128
    s_add_u32 m0, s31, 1024
    s_nop 0
    buffer_load_dwordx4 v12, s[12:15], s25 offen lds
    s_add_u32 s25, s25, 128
    s_add_u32 m0, s31, 2048
    s_nop 0
    buffer_load_dwordx4 v12, s[12:15], s26 offen lds
    s_add_u32 s26, s26, 128
    s_add_u32 m0, s31, 3072
    s_nop 0
    buffer_load_dwordx4 v12, s[12:15], s27 offen lds
    s_add_u32 s27, s27, 128
    s_waitcnt lgkmcnt(8)
    v_mfma_f32_16x16x32_bf16 v[32:35], v[96:99], v[112:115], v[32:35]
    v_mfma_f32_16x16x32_bf16 v[36:39], v[96:99], v[116:119], v[36:39]
    v_mfma_f32_16x16x32_bf16 v[40:43], v[96:99], v[120:123], v[40:43]
    v_mfma_f32_16x16x32_bf16 v[44:47], v[96:99], v[124:127], v[44:47]
    v_mfma_f32_16x16x32_bf16 v[48:51], v[100:103], v[112:115], v[48:51]
    v_mfma_f32_16x16x32_bf16 v[52:55], v[100:103], v[116:119], v[52:55]
    v_mfma_f32_16x16x32_bf16 v[56:59], v[100:103], v[120:123], v[56:59]
    v_mfma_f32_16x16x32_bf16 v[60:63], v[100:103], v[124:127], v[60:63]
    v_mfma_f32_16x16x32_bf16 v[64:67], v[104:107], v[112:115], v[64:67]
    v_mfma_f32_16x16x32_bf16 v[68:71], v[104:107], v[116:119], v[68:71]
    v_mfma_f32_16x16x32_bf16 v[72:75], v[104:107], v[120:123], v[72:75]
    v_mfma_f32_16x16x32_bf16 v[76:79], v[104:107], v[124:127], v[76:79]
    v_mfma_f32_16x16x32_bf16 v[80:83], v[108:111], v[112:115], v[80:83]
    v_mfma_f32_16x16x32_bf16 v[84:87], v[108:111], v[116:119], v[84:87]
    v_mfma_f32_16x16x32_bf16 v[88:91], v[108:111], v[120:123], v[88:91]
    v_mfma_f32_16x16x32_bf16 v[92:95], v[108:111], v[124:127], v[92:95]
    s_waitcnt lgkmcnt(0)
    v_mfma_f32_16x16x32_bf16 v[32:35], v[128:131], v[144:147], v[32:35]
    v_mfma_f32_16x16x32_bf16 v[36:39], v[128:131], v[148:151], v[36:39]
    v_mfma_f32_16x16x32_bf16 v[40:43], v[128:131], v[152:155], v[40:43]
    v_mfma_f32_16x16x32_bf16 v[44:47], v[128:131], v[156:159], v[44:47]
    v_mfma_f32_16x16x32_bf16 v[48:51], v[132:135], v[144:147], v[48:51]
    v_mfma_f32_16x16x32_bf16 v[52:55], v[132:135], v[148:151], v[52:55]
    v_mfma_f32_16x16x32_bf16 v[56:59], v[132:135], v[152:155], v[56:59]
    v_mfma_f32_16x16x32_bf16 v[60:63], v[132:135], v[156:159], v[60:63]
    v_mfma_f32_16x16x32_bf16 v[64:67], v[136:139], v[144:147], v[64:67]
    v_mfma_f32_16x16x32_bf16 v[68:71], v[136:139], v[148:151], v[68:71]
    v_mfma_f32_16x16x32_bf16 v[72:75], v[136:139], v[152:155], v[72:75]
    v_mfma_f32_16x16x32_bf16 v[76:79], v[136:139], v[156:159], v[76:79]
    v_mfma_f32_16x16x32_bf16 v[80:83], v[140:143], v[144:147], v[80:83]
    v_mfma_f32_16x16x32_bf16 v[84:87], v[140:143], v[148:151], v[84:87]
    v_mfma_f32_16x16x32_bf16 v[88:91], v[140:143], v[152:155], v[88:91]
    v_mfma_f32_16x16x32_bf16 v[92:95], v[140:143], v[156:159], v[92:95]
    s_add_u32 s33, s33, 1
    s_cmp_lt_u32 s33, 4
    s_cbranch_scc1 kloop_1
    s_waitcnt vmcnt(0)
    s_barrier
    ds_read_b128 v[96:99], v14 offset:0
    ds_read_b128 v[100:103], v14 offset:2048
    ds_read_b128 v[104:107], v14 offset:4096
    ds_read_b128 v[108:111], v14 offset:6144
    ds_read_b128 v[112:115], v16 offset:0
    ds_read_b128 v[116:119], v16 offset:2048
    ds_read_b128 v[120:123], v16 offset:8192
    ds_read_b128 v[124:127], v16 offset:10240
    ds_read_b128 v[128:131], v15 offset:0
    ds_read_b128 v[132:135], v15 offset:2048
    ds_read_b128 v[136:139], v15 offset:4096
    ds_read_b128 v[140:143], v15 offset:6144
    ds_read_b128 v[144:147], v17 offset:0
    ds_read_b128 v[148:151], v17 offset:2048
    ds_read_b128 v[152:155], v17 offset:8192
    ds_read_b128 v[156:159], v17 offset:10240
    s_waitcnt lgkmcnt(8)
    v_mfma_f32_16x16x32_bf16 v[32:35], v[96:99], v[112:115], v[32:35]
    v_mfma_f32_16x16x32_bf16 v[36:39], v[96:99], v[116:119], v[36:39]
    v_mfma_f32_16x16x32_bf16 v[40:43], v[96:99], v[120:123], v[40:43]
    v_mfma_f32_16x16x32_bf16 v[44:47], v[96:99], v[124:127], v[44:47]
    v_mfma_f32_16x16x32_bf16 v[48:51], v[100:103], v[112:115], v[48:51]
    v_mfma_f32_16x16x32_bf16 v[52:55], v[100:103], v[116:119], v[52:55]
    v_mfma_f32_16x16x32_bf16 v[56:59], v[100:103], v[120:123], v[56:59]
    v_mfma_f32_16x16x32_bf16 v[60:63], v[100:103], v[124:127], v[60:63]
    v_mfma_f32_16x16x32_bf16 v[64:67], v[104:107], v[112:115], v[64:67]
    v_mfma_f32_16x16x32_bf16 v[68:71], v[104:107], v[116:119], v[68:71]
    v_mfma_f32_16x16x32_bf16 v[72:75], v[104:107], v[120:123], v[72:75]
    v_mfma_f32_16x16x32_bf16 v[76:79], v[104:107], v[124:127], v[76:79]
    v_mfma_f32_16x16x32_bf16 v[80:83], v[108:111], v[112:115], v[80:83]
    v_mfma_f32_16x16x32_bf16 v[84:87], v[108:111], v[116:119], v[84:87]
    v_mfma_f32_16x16x32_bf16 v[88:91], v[108:111], v[120:123], v[88:91]
    v_mfma_f32_16x16x32_bf16 v[92:95], v[108:111], v[124:127], v[92:95]
    s_waitcnt lgkmcnt(0)
    v_mfma_f32_16x16x32_bf16 v[32:35], v[128:131], v[144:147], v[32:35]
    v_mfma_f32_16x16x32_bf16 v[36:39], v[128:131], v[148:151], v[36:39]
    v_mfma_f32_16x16x32_bf16 v[40:43], v[128:131], v[152:155], v[40:43]
    v_mfma_f32_16x16x32_bf16 v[44:47], v[128:131], v[156:159], v[44:47]
    v_mfma_f32_16x16x32_bf16 v[48:51], v[132:135], v[144:147], v[48:51]
    v_mfma_f32_16x16x32_bf16 v[52:55], v[132:135], v[148:151], v[52:55]
    v_mfma_f32_16x16x32_bf16 v[56:59], v[132:135], v[152:155], v[56:59]
    v_mfma_f32_16x16x32_bf16 v[60:63], v[132:135], v[156:159], v[60:63]
    v_mfma_f32_16x16x32_bf16 v[64:67], v[136:139], v[144:147], v[64:67]
    v_mfma_f32_16x16x32_bf16 v[68:71], v[136:139], v[148:151], v[68:71]
    v_mfma_f32_16x16x32_bf16 v[72:75], v[136:139], v[152:155], v[72:75]
    v_mfma_f32_16x16x32_bf16 v[76:79], v[136:139], v[156:159], v[76:79]
    v_mfma_f32_16x16x32_bf16 v[80:83], v[140:143], v[144:147], v[80:83]
    v_mfma_f32_16x16x32_bf16 v[84:87], v[140:143], v[148:151], v[84:87]
    v_mfma_f32_16x16x32_bf16 v[88:91], v[140:143], v[152:155], v[88:91]
    v_mfma_f32_16x16x32_bf16 v[92:95], v[140:143], v[156:159], v[92:95]
    s_nop 7
    s_nop 7
    s_add_u32 s16, s4, 0x400000
    s_addc_u32 s17, s5, 0
    s_and_b32 s17, s17, 0xffff
    s_mov_b32 s18, 0x640000
    s_mov_b32 s19, 0x00020000
    v_and_b32 v1, 15, v10
    s_and_b32 s38, s32, 1
    s_lshl_b32 s38, s38, 5
    s_add_u32 s38, s38, s37
    v_add_u32 v1, s38, v1
    v_lshlrev_b32 v1, 12, v1
    v_lshrrev_b32 v2, 4, v10
    v_lshlrev_b32 v2, 3, v2
    s_lshr_b32 s39, s32, 1
    s_lshl_b32 s39, s39, 6
    s_add_u32 s39, s39, s36
    s_lshl_b32 s39, s39, 1
    v_add3_u32 v1, v1, v2, s39
    v_cvt_pk_bf16_f32 v100, v32, v33
    v_cvt_pk_bf16_f32 v101, v34, v35
    s_mov_b32 s34, 0
    buffer_store_dwordx2 v[100:101], v1, s[16:19], s34 offen
    s_nop 0
    v_cvt_pk_bf16_f32 v100, v36, v37
    v_cvt_pk_bf16_f32 v101, v38, v39
    s_mov_b32 s34, 65536
    buffer_store_dwordx2 v[100:101], v1, s[16:19], s34 offen
    s_nop 0
    v_cvt_pk_bf16_f32 v100, v40, v41
    v_cvt_pk_bf16_f32 v101, v42, v43
    s_mov_b32 s34, 4194304
    buffer_store_dwordx2 v[100:101], v1, s[16:19], s34 offen
    s_nop 0
    v_cvt_pk_bf16_f32 v100, v44, v45
    v_cvt_pk_bf16_f32 v101, v46, v47
    s_mov_b32 s34, 4259840
    buffer_store_dwordx2 v[100:101], v1, s[16:19], s34 offen
    s_nop 0
    v_cvt_pk_bf16_f32 v100, v48, v49
    v_cvt_pk_bf16_f32 v101, v50, v51
    s_mov_b32 s34, 32
    buffer_store_dwordx2 v[100:101], v1, s[16:19], s34 offen
    s_nop 0
    v_cvt_pk_bf16_f32 v100, v52, v53
    v_cvt_pk_bf16_f32 v101, v54, v55
    s_mov_b32 s34, 65568
    buffer_store_dwordx2 v[100:101], v1, s[16:19], s34 offen
    s_nop 0
    v_cvt_pk_bf16_f32 v100, v56, v57
    v_cvt_pk_bf16_f32 v101, v58, v59
    s_mov_b32 s34, 4194336
    buffer_store_dwordx2 v[100:101], v1, s[16:19], s34 offen
    s_nop 0
    v_cvt_pk_bf16_f32 v100, v60, v61
    v_cvt_pk_bf16_f32 v101, v62, v63
    s_mov_b32 s34, 4259872
    buffer_store_dwordx2 v[100:101], v1, s[16:19], s34 offen
    s_nop 0
    v_cvt_pk_bf16_f32 v100, v64, v65
    v_cvt_pk_bf16_f32 v101, v66, v67
    s_mov_b32 s34, 64
    buffer_store_dwordx2 v[100:101], v1, s[16:19], s34 offen
    s_nop 0
    v_cvt_pk_bf16_f32 v100, v68, v69
    v_cvt_pk_bf16_f32 v101, v70, v71
    s_mov_b32 s34, 65600
    buffer_store_dwordx2 v[100:101], v1, s[16:19], s34 offen
    s_nop 0
    v_cvt_pk_bf16_f32 v100, v72, v73
    v_cvt_pk_bf16_f32 v101, v74, v75
    s_mov_b32 s34, 4194368
    buffer_store_dwordx2 v[100:101], v1, s[16:19], s34 offen
    s_nop 0
    v_cvt_pk_bf16_f32 v100, v76, v77
    v_cvt_pk_bf16_f32 v101, v78, v79
    s_mov_b32 s34, 4259904
    buffer_store_dwordx2 v[100:101], v1, s[16:19], s34 offen
    s_nop 0
    v_cvt_pk_bf16_f32 v100, v80, v81
    v_cvt_pk_bf16_f32 v101, v82, v83
    s_mov_b32 s34, 96
    buffer_store_dwordx2 v[100:101], v1, s[16:19], s34 offen
    s_nop 0
    v_cvt_pk_bf16_f32 v100, v84, v85
    v_cvt_pk_bf16_f32 v101, v86, v87
    s_mov_b32 s34, 65632
    buffer_store_dwordx2 v[100:101], v1, s[16:19], s34 offen
    s_nop 0
    v_cvt_pk_bf16_f32 v100, v88, v89
    v_cvt_pk_bf16_f32 v101, v90, v91
    s_mov_b32 s34, 4194400
    buffer_store_dwordx2 v[100:101], v1, s[16:19], s34 offen
    s_nop 0
    v_cvt_pk_bf16_f32 v100, v92, v93
    v_cvt_pk_bf16_f32 v101, v94, v95
    s_mov_b32 s34, 4259936
    buffer_store_dwordx2 v[100:101], v1, s[16:19], s34 offen
    s_nop 0
    s_waitcnt vmcnt(0)
    s_endpgm
k1_gu:
    s_sub_u32 s34, s2, 144
    s_and_b32 s35, s34, 7
    s_lshr_b32 s34, s34, 3
    s_mul_i32 s36, s34, 7282
    s_lshr_b32 s36, s36, 16
    s_mul_i32 s37, s36, 9
    s_sub_u32 s37, s34, s37
    s_lshl_b32 s37, s37, 3
    s_add_u32 s37, s37, s35
    s_lshl_b32 s36, s36, 7
    s_lshl_b32 s37, s37, 6
    s_cmp_ge_u32 s32, 2
    s_cselect_b32 s6, s46, s44
    s_cselect_b32 s7, s47, s45
    s_mov_b32 s12, s6
    s_mov_b32 s13, s7
    s_and_b32 s13, s13, 0xffff
    s_mov_b32 s14, 0x510000
    s_mov_b32 s15, 0x00020000
    v_lshrrev_b32 v1, 3, v10
    v_and_b32 v2, 7, v10
    v_xor_b32 v2, v2, v1
    v_lshlrev_b32 v2, 4, v2
    s_lshl_b32 s34, s32, 5
    v_add_u32 v3, s34, v1
    s_mov_b32 s34, 1152
    v_mul_lo_u32 v3, s34, v3
    v_add_u32 v11, v3, v2
    s_mul_i32 s34, s36, 1152
    s_add_u32 s20, s34, 0
    s_add_u32 s21, s34, 9216
    s_add_u32 s22, s34, 18432
    s_add_u32 s23, s34, 27648
    v_lshrrev_b32 v1, 3, v10
    s_mov_b32 s34, 9216
    v_mul_lo_u32 v3, s34, v1
    v_and_b32 v4, 2, v1
    v_and_b32 v5, 7, v10
    v_xor_b32 v5, v5, v4
    v_lshl_add_u32 v12, v5, 4, v3
    v_xor_b32 v13, 64, v12
    v_and_b32 v4, 15, v10
    v_lshrrev_b32 v5, 4, v10
    v_lshrrev_b32 v6, 2, v4
    v_lshl_add_u32 v7, v5, 3, v6
    v_lshlrev_b32 v7, 7, v7
    v_and_b32 v6, 2, v6
    v_and_b32 v5, 1, v5
    v_lshl_or_b32 v6, v5, 2, v6
    v_bfe_u32 v5, v4, 1, 1
    v_xor_b32 v5, v5, v6
    v_lshl_add_u32 v7, v5, 4, v7
    v_and_b32 v5, 1, v4
    v_lshl_add_u32 v8, v5, 3, v7
    v_add_u32 v8, 0x4000, v8
    s_mul_i32 s31, s32, 4096
    s_add_u32 s31, s31, 16384
    s_and_b32 s38, s32, 1
    s_mul_i32 s38, s38, 294912
    s_lshl_b32 s39, s37, 1
    s_add_u32 s38, s38, s39
    s_add_u32 s24, s38, 0
    s_add_u32 s25, s38, 73728
    s_add_u32 s26, s38, 147456
    s_add_u32 s27, s38, 221184
    s_and_b32 s38, s32, 1
    s_lshl_b32 s38, s38, 6
    v_xor_b32 v16, s38, v8
    v_xor_b32 v17, 32, v16
    v_add_u32 v22, 0x10000, v14
    v_add_u32 v23, 0x10000, v15
    v_add_u32 v24, 0x10000, v16
    v_add_u32 v25, 0x10000, v17
    v_add_u32 v26, 0x10000, v18
    v_add_u32 v27, 0x10000, v19
    v_add_u32 v28, 0x10000, v20
    v_add_u32 v29, 0x10000, v21
    v_mov_b32 v32, 0
    v_mov_b32 v33, 0
    v_mov_b32 v34, 0
    v_mov_b32 v35, 0
    v_mov_b32 v36, 0
    v_mov_b32 v37, 0
    v_mov_b32 v38, 0
    v_mov_b32 v39, 0
    v_mov_b32 v40, 0
    v_mov_b32 v41, 0
    v_mov_b32 v42, 0
    v_mov_b32 v43, 0
    v_mov_b32 v44, 0
    v_mov_b32 v45, 0
    v_mov_b32 v46, 0
    v_mov_b32 v47, 0
    v_mov_b32 v48, 0
    v_mov_b32 v49, 0
    v_mov_b32 v50, 0
    v_mov_b32 v51, 0
    v_mov_b32 v52, 0
    v_mov_b32 v53, 0
    v_mov_b32 v54, 0
    v_mov_b32 v55, 0
    v_mov_b32 v56, 0
    v_mov_b32 v57, 0
    v_mov_b32 v58, 0
    v_mov_b32 v59, 0
    v_mov_b32 v60, 0
    v_mov_b32 v61, 0
    v_mov_b32 v62, 0
    v_mov_b32 v63, 0
    v_mov_b32 v64, 0
    v_mov_b32 v65, 0
    v_mov_b32 v66, 0
    v_mov_b32 v67, 0
    v_mov_b32 v68, 0
    v_mov_b32 v69, 0
    v_mov_b32 v70, 0
    v_mov_b32 v71, 0
    v_mov_b32 v72, 0
    v_mov_b32 v73, 0
    v_mov_b32 v74, 0
    v_mov_b32 v75, 0
    v_mov_b32 v76, 0
    v_mov_b32 v77, 0
    v_mov_b32 v78, 0
    v_mov_b32 v79, 0
    v_mov_b32 v80, 0
    v_mov_b32 v81, 0
    v_mov_b32 v82, 0
    v_mov_b32 v83, 0
    v_mov_b32 v84, 0
    v_mov_b32 v85, 0
    v_mov_b32 v86, 0
    v_mov_b32 v87, 0
    v_mov_b32 v88, 0
    v_mov_b32 v89, 0
    v_mov_b32 v90, 0
    v_mov_b32 v91, 0
    v_mov_b32 v92, 0
    v_mov_b32 v93, 0
    v_mov_b32 v94, 0
    v_mov_b32 v95, 0
    s_add_u32 m0, s30, 0
    s_nop 0
    buffer_load_dwordx4 v11, s[8:11], s20 offen lds
    s_add_u32 s20, s20, 128
    s_add_u32 m0, s30, 1024
    s_nop 0
    buffer_load_dwordx4 v11, s[8:11], s21 offen lds
    s_add_u32 s21, s21, 128
    s_add_u32 m0, s30, 2048
    s_nop 0
    buffer_load_dwordx4 v11, s[8:11], s22 offen lds
    s_add_u32 s22, s22, 128
    s_add_u32 m0, s30, 3072
    s_nop 0
    buffer_load_dwordx4 v11, s[8:11], s23 offen lds
    s_add_u32 s23, s23, 128
    s_add_u32 m0, s31, 0
    s_nop 0
    buffer_load_dwordx4 v12, s[12:15], s24 offen lds
    s_add_u32 s24, s24, 589824
    s_add_u32 m0, s31, 1024
    s_nop 0
    buffer_load_dwordx4 v13, s[12:15], s25 offen lds
    s_add_u32 s25, s25, 589824
    s_add_u32 m0, s31, 2048
    s_nop 0
    buffer_load_dwordx4 v12, s[12:15], s26 offen lds
    s_add_u32 s26, s26, 589824
    s_add_u32 m0, s31, 3072
    s_nop 0
    buffer_load_dwordx4 v13, s[12:15], s27 offen lds
    s_add_u32 s27, s27, 589824
    s_mov_b32 s33, 0
kloop_2:
    s_waitcnt vmcnt(0)
    s_barrier
    ds_read_b128 v[96:99], v14 offset:0
    ds_read_b128 v[100:103], v14 offset:2048
    ds_read_b128 v[104:107], v14 offset:4096
    ds_read_b128 v[108:111], v14 offset:6144
    ds_read_b64_tr_b16 v[112:113], v16 offset:0
    ds_read_b64_tr_b16 v[114:115], v16 offset:512
    ds_read_b64_tr_b16 v[116:117], v17 offset:0
    ds_read_b64_tr_b16 v[118:119], v17 offset:512
    ds_read_b64_tr_b16 v[120:121], v16 offset:8192
    ds_read_b64_tr_b16 v[122:123], v16 offset:8704
    ds_read_b64_tr_b16 v[124:125], v17 offset:8192
    ds_read_b64_tr_b16 v[126:127], v17 offset:8704
    ds_read_b128 v[128:131], v15 offset:0
    ds_read_b128 v[132:135], v15 offset:2048
    ds_read_b128 v[136:139], v15 offset:4096
    ds_read_b128 v[140:143], v15 offset:6144
    ds_read_b64_tr_b16 v[144:145], v16 offset:4096
    ds_read_b64_tr_b16 v[146:147], v16 offset:4608
    ds_read_b64_tr_b16 v[148:149], v17 offset:4096
    ds_read_b64_tr_b16 v[150:151], v17 offset:4608
    ds_read_b64_tr_b16 v[152:153], v16 offset:12288
    ds_read_b64_tr_b16 v[154:155], v16 offset:12800
    ds_read_b64_tr_b16 v[156:157], v17 offset:12288
    ds_read_b64_tr_b16 v[158:159], v17 offset:12800
    s_add_u32 m0, s30, 32768
    s_nop 0
    buffer_load_dwordx4 v11, s[8:11], s20 offen lds
    s_add_u32 s20, s20, 128
    s_add_u32 m0, s30, 33792
    s_nop 0
    buffer_load_dwordx4 v11, s[8:11], s21 offen lds
    s_add_u32 s21, s21, 128
    s_add_u32 m0, s30, 34816
    s_nop 0
    buffer_load_dwordx4 v11, s[8:11], s22 offen lds
    s_add_u32 s22, s22, 128
    s_add_u32 m0, s30, 35840
    s_nop 0
    buffer_load_dwordx4 v11, s[8:11], s23 offen lds
    s_add_u32 s23, s23, 128
    s_add_u32 m0, s31, 32768
    s_nop 0
    buffer_load_dwordx4 v12, s[12:15], s24 offen lds
    s_add_u32 s24, s24, 589824
    s_add_u32 m0, s31, 33792
    s_nop 0
    buffer_load_dwordx4 v13, s[12:15], s25 offen lds
    s_add_u32 s25, s25, 589824
    s_add_u32 m0, s31, 34816
    s_nop 0
    buffer_load_dwordx4 v12, s[12:15], s26 offen lds
    s_add_u32 s26, s26, 589824
    s_add_u32 m0, s31, 35840
    s_nop 0
    buffer_load_dwordx4 v13, s[12:15], s27 offen lds
    s_add_u32 s27, s27, 589824
    s_waitcnt lgkmcnt(12)
    v_mfma_f32_16x16x32_bf16 v[32:35], v[112:115], v[96:99], v[32:35]
    v_mfma_f32_16x16x32_bf16 v[36:39], v[116:119], v[96:99], v[36:39]
    v_mfma_f32_16x16x32_bf16 v[40:43], v[120:123], v[96:99], v[40:43]
    v_mfma_f32_16x16x32_bf16 v[44:47], v[124:127], v[96:99], v[44:47]
    v_mfma_f32_16x16x32_bf16 v[48:51], v[112:115], v[100:103], v[48:51]
    v_mfma_f32_16x16x32_bf16 v[52:55], v[116:119], v[100:103], v[52:55]
    v_mfma_f32_16x16x32_bf16 v[56:59], v[120:123], v[100:103], v[56:59]
    v_mfma_f32_16x16x32_bf16 v[60:63], v[124:127], v[100:103], v[60:63]
    v_mfma_f32_16x16x32_bf16 v[64:67], v[112:115], v[104:107], v[64:67]
    v_mfma_f32_16x16x32_bf16 v[68:71], v[116:119], v[104:107], v[68:71]
    v_mfma_f32_16x16x32_bf16 v[72:75], v[120:123], v[104:107], v[72:75]
    v_mfma_f32_16x16x32_bf16 v[76:79], v[124:127], v[104:107], v[76:79]
    v_mfma_f32_16x16x32_bf16 v[80:83], v[112:115], v[108:111], v[80:83]
    v_mfma_f32_16x16x32_bf16 v[84:87], v[116:119], v[108:111], v[84:87]
    v_mfma_f32_16x16x32_bf16 v[88:91], v[120:123], v[108:111], v[88:91]
    v_mfma_f32_16x16x32_bf16 v[92:95], v[124:127], v[108:111], v[92:95]
    s_waitcnt lgkmcnt(0)
    v_mfma_f32_16x16x32_bf16 v[32:35], v[144:147], v[128:131], v[32:35]
    v_mfma_f32_16x16x32_bf16 v[36:39], v[148:151], v[128:131], v[36:39]
    v_mfma_f32_16x16x32_bf16 v[40:43], v[152:155], v[128:131], v[40:43]
    v_mfma_f32_16x16x32_bf16 v[44:47], v[156:159], v[128:131], v[44:47]
    v_mfma_f32_16x16x32_bf16 v[48:51], v[144:147], v[132:135], v[48:51]
    v_mfma_f32_16x16x32_bf16 v[52:55], v[148:151], v[132:135], v[52:55]
    v_mfma_f32_16x16x32_bf16 v[56:59], v[152:155], v[132:135], v[56:59]
    v_mfma_f32_16x16x32_bf16 v[60:63], v[156:159], v[132:135], v[60:63]
    v_mfma_f32_16x16x32_bf16 v[64:67], v[144:147], v[136:139], v[64:67]
    v_mfma_f32_16x16x32_bf16 v[68:71], v[148:151], v[136:139], v[68:71]
    v_mfma_f32_16x16x32_bf16 v[72:75], v[152:155], v[136:139], v[72:75]
    v_mfma_f32_16x16x32_bf16 v[76:79], v[156:159], v[136:139], v[76:79]
    v_mfma_f32_16x16x32_bf16 v[80:83], v[144:147], v[140:143], v[80:83]
    v_mfma_f32_16x16x32_bf16 v[84:87], v[148:151], v[140:143], v[84:87]
    v_mfma_f32_16x16x32_bf16 v[88:91], v[152:155], v[140:143], v[88:91]
    v_mfma_f32_16x16x32_bf16 v[92:95], v[156:159], v[140:143], v[92:95]
    s_waitcnt vmcnt(0)
    s_barrier
    ds_read_b128 v[96:99], v14 offset:32768
    ds_read_b128 v[100:103], v14 offset:34816
    ds_read_b128 v[104:107], v14 offset:36864
    ds_read_b128 v[108:111], v14 offset:38912
    ds_read_b64_tr_b16 v[112:113], v16 offset:32768
    ds_read_b64_tr_b16 v[114:115], v16 offset:33280
    ds_read_b64_tr_b16 v[116:117], v17 offset:32768
    ds_read_b64_tr_b16 v[118:119], v17 offset:33280
    ds_read_b64_tr_b16 v[120:121], v16 offset:40960
    ds_read_b64_tr_b16 v[122:123], v16 offset:41472
    ds_read_b64_tr_b16 v[124:125], v17 offset:40960
    ds_read_b64_tr_b16 v[126:127], v17 offset:41472
    ds_read_b128 v[128:131], v15 offset:32768
    ds_read_b128 v[132:135], v15 offset:34816
    ds_read_b128 v[136:139], v15 offset:36864
    ds_read_b128 v[140:143], v15 offset:38912
    ds_read_b64_tr_b16 v[144:145], v16 offset:36864
    ds_read_b64_tr_b16 v[146:147], v16 offset:37376
    ds_read_b64_tr_b16 v[148:149], v17 offset:36864
    ds_read_b64_tr_b16 v[150:151], v17 offset:37376
    ds_read_b64_tr_b16 v[152:153], v16 offset:45056
    ds_read_b64_tr_b16 v[154:155], v16 offset:45568
    ds_read_b64_tr_b16 v[156:157], v17 offset:45056
    ds_read_b64_tr_b16 v[158:159], v17 offset:45568
    s_add_u32 m0, s30, 0
    s_nop 0
    buffer_load_dwordx4 v11, s[8:11], s20 offen lds
    s_add_u32 s20, s20, 128
    s_add_u32 m0, s30, 1024
    s_nop 0
    buffer_load_dwordx4 v11, s[8:11], s21 offen lds
    s_add_u32 s21, s21, 128
    s_add_u32 m0, s30, 2048
    s_nop 0
    buffer_load_dwordx4 v11, s[8:11], s22 offen lds
    s_add_u32 s22, s22, 128
    s_add_u32 m0, s30, 3072
    s_nop 0
    buffer_load_dwordx4 v11, s[8:11], s23 offen lds
    s_add_u32 s23, s23, 128
    s_add_u32 m0, s31, 0
    s_nop 0
    buffer_load_dwordx4 v12, s[12:15], s24 offen lds
    s_add_u32 s24, s24, 589824
    s_add_u32 m0, s31, 1024
    s_nop 0
    buffer_load_dwordx4 v13, s[12:15], s25 offen lds
    s_add_u32 s25, s25, 589824
    s_add_u32 m0, s31, 2048
    s_nop 0
    buffer_load_dwordx4 v12, s[12:15], s26 offen lds
    s_add_u32 s26, s26, 589824
    s_add_u32 m0, s31, 3072
    s_nop 0
    buffer_load_dwordx4 v13, s[12:15], s27 offen lds
    s_add_u32 s27, s27, 589824
    s_waitcnt lgkmcnt(12)
    v_mfma_f32_16x16x32_bf16 v[32:35], v[112:115], v[96:99], v[32:35]
    v_mfma_f32_16x16x32_bf16 v[36:39], v[116:119], v[96:99], v[36:39]
    v_mfma_f32_16x16x32_bf16 v[40:43], v[120:123], v[96:99], v[40:43]
    v_mfma_f32_16x16x32_bf16 v[44:47], v[124:127], v[96:99], v[44:47]
    v_mfma_f32_16x16x32_bf16 v[48:51], v[112:115], v[100:103], v[48:51]
    v_mfma_f32_16x16x32_bf16 v[52:55], v[116:119], v[100:103], v[52:55]
    v_mfma_f32_16x16x32_bf16 v[56:59], v[120:123], v[100:103], v[56:59]
    v_mfma_f32_16x16x32_bf16 v[60:63], v[124:127], v[100:103], v[60:63]
    v_mfma_f32_16x16x32_bf16 v[64:67], v[112:115], v[104:107], v[64:67]
    v_mfma_f32_16x16x32_bf16 v[68:71], v[116:119], v[104:107], v[68:71]
    v_mfma_f32_16x16x32_bf16 v[72:75], v[120:123], v[104:107], v[72:75]
    v_mfma_f32_16x16x32_bf16 v[76:79], v[124:127], v[104:107], v[76:79]
    v_mfma_f32_16x16x32_bf16 v[80:83], v[112:115], v[108:111], v[80:83]
    v_mfma_f32_16x16x32_bf16 v[84:87], v[116:119], v[108:111], v[84:87]
    v_mfma_f32_16x16x32_bf16 v[88:91], v[120:123], v[108:111], v[88:91]
    v_mfma_f32_16x16x32_bf16 v[92:95], v[124:127], v[108:111], v[92:95]
    s_waitcnt lgkmcnt(0)
    v_mfma_f32_16x16x32_bf16 v[32:35], v[144:147], v[128:131], v[32:35]
    v_mfma_f32_16x16x32_bf16 v[36:39], v[148:151], v[128:131], v[36:39]
    v_mfma_f32_16x16x32_bf16 v[40:43], v[152:155], v[128:131], v[40:43]
    v_mfma_f32_16x16x32_bf16 v[44:47], v[156:159], v[128:131], v[44:47]
    v_mfma_f32_16x16x32_bf16 v[48:51], v[144:147], v[132:135], v[48:51]
    v_mfma_f32_16x16x32_bf16 v[52:55], v[148:151], v[132:135], v[52:55]
    v_mfma_f32_16x16x32_bf16 v[56:59], v[152:155], v[132:135], v[56:59]
    v_mfma_f32_16x16x32_bf16 v[60:63], v[156:159], v[132:135], v[60:63]
    v_mfma_f32_16x16x32_bf16 v[64:67], v[144:147], v[136:139], v[64:67]
    v_mfma_f32_16x16x32_bf16 v[68:71], v[148:151], v[136:139], v[68:71]
    v_mfma_f32_16x16x32_bf16 v[72:75], v[152:155], v[136:139], v[72:75]
    v_mfma_f32_16x16x32_bf16 v[76:79], v[156:159], v[136:139], v[76:79]
    v_mfma_f32_16x16x32_bf16 v[80:83], v[144:147], v[140:143], v[80:83]
    v_mfma_f32_16x16x32_bf16 v[84:87], v[148:151], v[140:143], v[84:87]
    v_mfma_f32_16x16x32_bf16 v[88:91], v[152:155], v[140:143], v[88:91]
    v_mfma_f32_16x16x32_bf16 v[92:95], v[156:159], v[140:143], v[92:95]
    s_add_u32 s33, s33, 1
    s_cmp_lt_u32 s33, 4
    s_cbranch_scc1 kloop_2
    s_waitcnt vmcnt(0)
    s_barrier
    ds_read_b128 v[96:99], v14 offset:0
    ds_read_b128 v[100:103], v14 offset:2048
    ds_read_b128 v[104:107], v14 offset:4096
    ds_read_b128 v[108:111], v14 offset:6144
    ds_read_b64_tr_b16 v[112:113], v16 offset:0
    ds_read_b64_tr_b16 v[114:115], v16 offset:512
    ds_read_b64_tr_b16 v[116:117], v17 offset:0
    ds_read_b64_tr_b16 v[118:119], v17 offset:512
    ds_read_b64_tr_b16 v[120:121], v16 offset:8192
    ds_read_b64_tr_b16 v[122:123], v16 offset:8704
    ds_read_b64_tr_b16 v[124:125], v17 offset:8192
    ds_read_b64_tr_b16 v[126:127], v17 offset:8704
    ds_read_b128 v[128:131], v15 offset:0
    ds_read_b128 v[132:135], v15 offset:2048
    ds_read_b128 v[136:139], v15 offset:4096
    ds_read_b128 v[140:143], v15 offset:6144
    ds_read_b64_tr_b16 v[144:145], v16 offset:4096
    ds_read_b64_tr_b16 v[146:147], v16 offset:4608
    ds_read_b64_tr_b16 v[148:149], v17 offset:4096
    ds_read_b64_tr_b16 v[150:151], v17 offset:4608
    ds_read_b64_tr_b16 v[152:153], v16 offset:12288
    ds_read_b64_tr_b16 v[154:155], v16 offset:12800
    ds_read_b64_tr_b16 v[156:157], v17 offset:12288
    ds_read_b64_tr_b16 v[158:159], v17 offset:12800
    s_waitcnt lgkmcnt(12)
    v_mfma_f32_16x16x32_bf16 v[32:35], v[112:115], v[96:99], v[32:35]
    v_mfma_f32_16x16x32_bf16 v[36:39], v[116:119], v[96:99], v[36:39]
    v_mfma_f32_16x16x32_bf16 v[40:43], v[120:123], v[96:99], v[40:43]
    v_mfma_f32_16x16x32_bf16 v[44:47], v[124:127], v[96:99], v[44:47]
    v_mfma_f32_16x16x32_bf16 v[48:51], v[112:115], v[100:103], v[48:51]
    v_mfma_f32_16x16x32_bf16 v[52:55], v[116:119], v[100:103], v[52:55]
    v_mfma_f32_16x16x32_bf16 v[56:59], v[120:123], v[100:103], v[56:59]
    v_mfma_f32_16x16x32_bf16 v[60:63], v[124:127], v[100:103], v[60:63]
    v_mfma_f32_16x16x32_bf16 v[64:67], v[112:115], v[104:107], v[64:67]
    v_mfma_f32_16x16x32_bf16 v[68:71], v[116:119], v[104:107], v[68:71]
    v_mfma_f32_16x16x32_bf16 v[72:75], v[120:123], v[104:107], v[72:75]
    v_mfma_f32_16x16x32_bf16 v[76:79], v[124:127], v[104:107], v[76:79]
    v_mfma_f32_16x16x32_bf16 v[80:83], v[112:115], v[108:111], v[80:83]
    v_mfma_f32_16x16x32_bf16 v[84:87], v[116:119], v[108:111], v[84:87]
    v_mfma_f32_16x16x32_bf16 v[88:91], v[120:123], v[108:111], v[88:91]
    v_mfma_f32_16x16x32_bf16 v[92:95], v[124:127], v[108:111], v[92:95]
    s_waitcnt lgkmcnt(0)
    v_mfma_f32_16x16x32_bf16 v[32:35], v[144:147], v[128:131], v[32:35]
    v_mfma_f32_16x16x32_bf16 v[36:39], v[148:151], v[128:131], v[36:39]
    v_mfma_f32_16x16x32_bf16 v[40:43], v[152:155], v[128:131], v[40:43]
    v_mfma_f32_16x16x32_bf16 v[44:47], v[156:159], v[128:131], v[44:47]
    v_mfma_f32_16x16x32_bf16 v[48:51], v[144:147], v[132:135], v[48:51]
    v_mfma_f32_16x16x32_bf16 v[52:55], v[148:151], v[132:135], v[52:55]
    v_mfma_f32_16x16x32_bf16 v[56:59], v[152:155], v[132:135], v[56:59]
    v_mfma_f32_16x16x32_bf16 v[60:63], v[156:159], v[132:135], v[60:63]
    v_mfma_f32_16x16x32_bf16 v[64:67], v[144:147], v[136:139], v[64:67]
    v_mfma_f32_16x16x32_bf16 v[68:71], v[148:151], v[136:139], v[68:71]
    v_mfma_f32_16x16x32_bf16 v[72:75], v[152:155], v[136:139], v[72:75]
    v_mfma_f32_16x16x32_bf16 v[76:79], v[156:159], v[136:139], v[76:79]
    v_mfma_f32_16x16x32_bf16 v[80:83], v[144:147], v[140:143], v[80:83]
    v_mfma_f32_16x16x32_bf16 v[84:87], v[148:151], v[140:143], v[84:87]
    v_mfma_f32_16x16x32_bf16 v[88:91], v[152:155], v[140:143], v[88:91]
    v_mfma_f32_16x16x32_bf16 v[92:95], v[156:159], v[140:143], v[92:95]
    s_nop 7
    s_nop 7
    s_add_u32 s16, s4, 0x1000000
    s_addc_u32 s17, s5, 0
    s_and_b32 s17, s17, 0xffff
    s_mov_b32 s18, 0x1200000
    s_mov_b32 s19, 0x00020000
    v_and_b32 v1, 15, v10
    s_lshr_b32 s39, s32, 1
    s_lshl_b32 s39, s39, 6
    s_add_u32 s39, s39, s36
    v_add_u32 v1, s39, v1
    s_movk_i32 s39, 9216
    v_mul_lo_u32 v1, s39, v1
    v_lshrrev_b32 v2, 4, v10
    v_lshlrev_b32 v2, 3, v2
    s_and_b32 s38, s32, 1
    s_lshl_b32 s38, s38, 5
    s_add_u32 s38, s38, s37
    s_lshl_b32 s38, s38, 1
    v_add3_u32 v1, v1, v2, s38
    v_cvt_pk_bf16_f32 v100, v32, v33
    v_cvt_pk_bf16_f32 v101, v34, v35
    v_cvt_pk_bf16_f32 v102, v40, v41
    v_cvt_pk_bf16_f32 v103, v42, v43
    v_lshlrev_b32 v104, 16, v100
    v_and_b32 v105, 0xffff0000, v100
    v_lshlrev_b32 v106, 16, v101
    v_and_b32 v107, 0xffff0000, v101
    v_mul_f32 v104, 0xbfb8aa3b, v104
    v_mul_f32 v105, 0xbfb8aa3b, v105
    v_mul_f32 v106, 0xbfb8aa3b, v106
    v_mul_f32 v107, 0xbfb8aa3b, v107
    v_exp_f32 v104, v104
    v_exp_f32 v105, v105
    v_exp_f32 v106, v106
    v_exp_f32 v107, v107
    v_add_f32 v104, 1.0, v104
    v_add_f32 v105, 1.0, v105
    v_add_f32 v106, 1.0, v106
    v_add_f32 v107, 1.0, v107
    v_rcp_f32 v104, v104
    v_rcp_f32 v105, v105
    v_rcp_f32 v106, v106
    v_rcp_f32 v107, v107
    s_nop 0
    v_cvt_pk_bf16_f32 v100, v104, v105
    v_cvt_pk_bf16_f32 v101, v106, v107
    v_lshlrev_b32 v104, 16, v100
    v_and_b32 v105, 0xffff0000, v100
    v_lshlrev_b32 v106, 16, v101
    v_and_b32 v107, 0xffff0000, v101
    v_lshlrev_b32 v108, 16, v102
    v_and_b32 v109, 0xffff0000, v102
    v_lshlrev_b32 v110, 16, v103
    v_and_b32 v111, 0xffff0000, v103
    v_mul_f32 v104, v104, v108
    v_mul_f32 v105, v105, v109
    v_mul_f32 v106, v106, v110
    v_mul_f32 v107, v107, v111
    v_cvt_pk_bf16_f32 v112, v104, v105
    v_cvt_pk_bf16_f32 v113, v106, v107
    s_mov_b32 s34, 0
    buffer_store_dwordx2 v[112:113], v1, s[16:19], s34 offen
    v_cvt_pk_bf16_f32 v100, v36, v37
    v_cvt_pk_bf16_f32 v101, v38, v39
    v_cvt_pk_bf16_f32 v102, v44, v45
    v_cvt_pk_bf16_f32 v103, v46, v47
    v_lshlrev_b32 v104, 16, v100
    v_and_b32 v105, 0xffff0000, v100
    v_lshlrev_b32 v106, 16, v101
    v_and_b32 v107, 0xffff0000, v101
    v_mul_f32 v104, 0xbfb8aa3b, v104
    v_mul_f32 v105, 0xbfb8aa3b, v105
    v_mul_f32 v106, 0xbfb8aa3b, v106
    v_mul_f32 v107, 0xbfb8aa3b, v107
    v_exp_f32 v104, v104
    v_exp_f32 v105, v105
    v_exp_f32 v106, v106
    v_exp_f32 v107, v107
    v_add_f32 v104, 1.0, v104
    v_add_f32 v105, 1.0, v105
    v_add_f32 v106, 1.0, v106
    v_add_f32 v107, 1.0, v107
    v_rcp_f32 v104, v104
    v_rcp_f32 v105, v105
    v_rcp_f32 v106, v106
    v_rcp_f32 v107, v107
    s_nop 0
    v_cvt_pk_bf16_f32 v100, v104, v105
    v_cvt_pk_bf16_f32 v101, v106, v107
    v_lshlrev_b32 v104, 16, v100
    v_and_b32 v105, 0xffff0000, v100
    v_lshlrev_b32 v106, 16, v101
    v_and_b32 v107, 0xffff0000, v101
    v_lshlrev_b32 v108, 16, v102
    v_and_b32 v109, 0xffff0000, v102
    v_lshlrev_b32 v110, 16, v103
    v_and_b32 v111, 0xffff0000, v103
    v_mul_f32 v104, v104, v108
    v_mul_f32 v105, v105, v109
    v_mul_f32 v106, v106, v110
    v_mul_f32 v107, v107, v111
    v_cvt_pk_bf16_f32 v112, v104, v105
    v_cvt_pk_bf16_f32 v113, v106, v107
    s_mov_b32 s34, 32
    buffer_store_dwordx2 v[112:113], v1, s[16:19], s34 offen
    v_cvt_pk_bf16_f32 v100, v48, v49
    v_cvt_pk_bf16_f32 v101, v50, v51
    v_cvt_pk_bf16_f32 v102, v56, v57
    v_cvt_pk_bf16_f32 v103, v58, v59
    v_lshlrev_b32 v104, 16, v100
    v_and_b32 v105, 0xffff0000, v100
    v_lshlrev_b32 v106, 16, v101
    v_and_b32 v107, 0xffff0000, v101
    v_mul_f32 v104, 0xbfb8aa3b, v104
    v_mul_f32 v105, 0xbfb8aa3b, v105
    v_mul_f32 v106, 0xbfb8aa3b, v106
    v_mul_f32 v107, 0xbfb8aa3b, v107
    v_exp_f32 v104, v104
    v_exp_f32 v105, v105
    v_exp_f32 v106, v106
    v_exp_f32 v107, v107
    v_add_f32 v104, 1.0, v104
    v_add_f32 v105, 1.0, v105
    v_add_f32 v106, 1.0, v106
    v_add_f32 v107, 1.0, v107
    v_rcp_f32 v104, v104
    v_rcp_f32 v105, v105
    v_rcp_f32 v106, v106
    v_rcp_f32 v107, v107
    s_nop 0
    v_cvt_pk_bf16_f32 v100, v104, v105
    v_cvt_pk_bf16_f32 v101, v106, v107
    v_lshlrev_b32 v104, 16, v100
    v_and_b32 v105, 0xffff0000, v100
    v_lshlrev_b32 v106, 16, v101
    v_and_b32 v107, 0xffff0000, v101
    v_lshlrev_b32 v108, 16, v102
    v_and_b32 v109, 0xffff0000, v102
    v_lshlrev_b32 v110, 16, v103
    v_and_b32 v111, 0xffff0000, v103
    v_mul_f32 v104, v104, v108
    v_mul_f32 v105, v105, v109
    v_mul_f32 v106, v106, v110
    v_mul_f32 v107, v107, v111
    v_cvt_pk_bf16_f32 v112, v104, v105
    v_cvt_pk_bf16_f32 v113, v106, v107
    s_mov_b32 s34, 147456
    buffer_store_dwordx2 v[112:113], v1, s[16:19], s34 offen
    v_cvt_pk_bf16_f32 v100, v52, v53
    v_cvt_pk_bf16_f32 v101, v54, v55
    v_cvt_pk_bf16_f32 v102, v60, v61
    v_cvt_pk_bf16_f32 v103, v62, v63
    v_lshlrev_b32 v104, 16, v100
    v_and_b32 v105, 0xffff0000, v100
    v_lshlrev_b32 v106, 16, v101
    v_and_b32 v107, 0xffff0000, v101
    v_mul_f32 v104, 0xbfb8aa3b, v104
    v_mul_f32 v105, 0xbfb8aa3b, v105
    v_mul_f32 v106, 0xbfb8aa3b, v106
    v_mul_f32 v107, 0xbfb8aa3b, v107
    v_exp_f32 v104, v104
    v_exp_f32 v105, v105
    v_exp_f32 v106, v106
    v_exp_f32 v107, v107
    v_add_f32 v104, 1.0, v104
    v_add_f32 v105, 1.0, v105
    v_add_f32 v106, 1.0, v106
    v_add_f32 v107, 1.0, v107
    v_rcp_f32 v104, v104
    v_rcp_f32 v105, v105
    v_rcp_f32 v106, v106
    v_rcp_f32 v107, v107
    s_nop 0
    v_cvt_pk_bf16_f32 v100, v104, v105
    v_cvt_pk_bf16_f32 v101, v106, v107
    v_lshlrev_b32 v104, 16, v100
    v_and_b32 v105, 0xffff0000, v100
    v_lshlrev_b32 v106, 16, v101
    v_and_b32 v107, 0xffff0000, v101
    v_lshlrev_b32 v108, 16, v102
    v_and_b32 v109, 0xffff0000, v102
    v_lshlrev_b32 v110, 16, v103
    v_and_b32 v111, 0xffff0000, v103
    v_mul_f32 v104, v104, v108
    v_mul_f32 v105, v105, v109
    v_mul_f32 v106, v106, v110
    v_mul_f32 v107, v107, v111
    v_cvt_pk_bf16_f32 v112, v104, v105
    v_cvt_pk_bf16_f32 v113, v106, v107
    s_mov_b32 s34, 147488
    buffer_store_dwordx2 v[112:113], v1, s[16:19], s34 offen
    v_cvt_pk_bf16_f32 v100, v64, v65
    v_cvt_pk_bf16_f32 v101, v66, v67
    v_cvt_pk_bf16_f32 v102, v72, v73
    v_cvt_pk_bf16_f32 v103, v74, v75
    v_lshlrev_b32 v104, 16, v100
    v_and_b32 v105, 0xffff0000, v100
    v_lshlrev_b32 v106, 16, v101
    v_and_b32 v107, 0xffff0000, v101
    v_mul_f32 v104, 0xbfb8aa3b, v104
    v_mul_f32 v105, 0xbfb8aa3b, v105
    v_mul_f32 v106, 0xbfb8aa3b, v106
    v_mul_f32 v107, 0xbfb8aa3b, v107
    v_exp_f32 v104, v104
    v_exp_f32 v105, v105
    v_exp_f32 v106, v106
    v_exp_f32 v107, v107
    v_add_f32 v104, 1.0, v104
    v_add_f32 v105, 1.0, v105
    v_add_f32 v106, 1.0, v106
    v_add_f32 v107, 1.0, v107
    v_rcp_f32 v104, v104
    v_rcp_f32 v105, v105
    v_rcp_f32 v106, v106
    v_rcp_f32 v107, v107
    s_nop 0
    v_cvt_pk_bf16_f32 v100, v104, v105
    v_cvt_pk_bf16_f32 v101, v106, v107
    v_lshlrev_b32 v104, 16, v100
    v_and_b32 v105, 0xffff0000, v100
    v_lshlrev_b32 v106, 16, v101
    v_and_b32 v107, 0xffff0000, v101
    v_lshlrev_b32 v108, 16, v102
    v_and_b32 v109, 0xffff0000, v102
    v_lshlrev_b32 v110, 16, v103
    v_and_b32 v111, 0xffff0000, v103
    v_mul_f32 v104, v104, v108
    v_mul_f32 v105, v105, v109
    v_mul_f32 v106, v106, v110
    v_mul_f32 v107, v107, v111
    v_cvt_pk_bf16_f32 v112, v104, v105
    v_cvt_pk_bf16_f32 v113, v106, v107
    s_mov_b32 s34, 294912
    buffer_store_dwordx2 v[112:113], v1, s[16:19], s34 offen
    v_cvt_pk_bf16_f32 v100, v68, v69
    v_cvt_pk_bf16_f32 v101, v70, v71
    v_cvt_pk_bf16_f32 v102, v76, v77
    v_cvt_pk_bf16_f32 v103, v78, v79
    v_lshlrev_b32 v104, 16, v100
    v_and_b32 v105, 0xffff0000, v100
    v_lshlrev_b32 v106, 16, v101
    v_and_b32 v107, 0xffff0000, v101
    v_mul_f32 v104, 0xbfb8aa3b, v104
    v_mul_f32 v105, 0xbfb8aa3b, v105
    v_mul_f32 v106, 0xbfb8aa3b, v106
    v_mul_f32 v107, 0xbfb8aa3b, v107
    v_exp_f32 v104, v104
    v_exp_f32 v105, v105
    v_exp_f32 v106, v106
    v_exp_f32 v107, v107
    v_add_f32 v104, 1.0, v104
    v_add_f32 v105, 1.0, v105
    v_add_f32 v106, 1.0, v106
    v_add_f32 v107, 1.0, v107
    v_rcp_f32 v104, v104
    v_rcp_f32 v105, v105
    v_rcp_f32 v106, v106
    v_rcp_f32 v107, v107
    s_nop 0
    v_cvt_pk_bf16_f32 v100, v104, v105
    v_cvt_pk_bf16_f32 v101, v106, v107
    v_lshlrev_b32 v104, 16, v100
    v_and_b32 v105, 0xffff0000, v100
    v_lshlrev_b32 v106, 16, v101
    v_and_b32 v107, 0xffff0000, v101
    v_lshlrev_b32 v108, 16, v102
    v_and_b32 v109, 0xffff0000, v102
    v_lshlrev_b32 v110, 16, v103
    v_and_b32 v111, 0xffff0000, v103
    v_mul_f32 v104, v104, v108
    v_mul_f32 v105, v105, v109
    v_mul_f32 v106, v106, v110
    v_mul_f32 v107, v107, v111
    v_cvt_pk_bf16_f32 v112, v104, v105
    v_cvt_pk_bf16_f32 v113, v106, v107
    s_mov_b32 s34, 294944
    buffer_store_dwordx2 v[112:113], v1, s[16:19], s34 offen
    v_cvt_pk_bf16_f32 v100, v80, v81
    v_cvt_pk_bf16_f32 v101, v82, v83
    v_cvt_pk_bf16_f32 v102, v88, v89
    v_cvt_pk_bf16_f32 v103, v90, v91
    v_lshlrev_b32 v104, 16, v100
    v_and_b32 v105, 0xffff0000, v100
    v_lshlrev_b32 v106, 16, v101
    v_and_b32 v107, 0xffff0000, v101
    v_mul_f32 v104, 0xbfb8aa3b, v104
    v_mul_f32 v105, 0xbfb8aa3b, v105
    v_mul_f32 v106, 0xbfb8aa3b, v106
    v_mul_f32 v107, 0xbfb8aa3b, v107
    v_exp_f32 v104, v104
    v_exp_f32 v105, v105
    v_exp_f32 v106, v106
    v_exp_f32 v107, v107
    v_add_f32 v104, 1.0, v104
    v_add_f32 v105, 1.0, v105
    v_add_f32 v106, 1.0, v106
    v_add_f32 v107, 1.0, v107
    v_rcp_f32 v104, v104
    v_rcp_f32 v105, v105
    v_rcp_f32 v106, v106
    v_rcp_f32 v107, v107
    s_nop 0
    v_cvt_pk_bf16_f32 v100, v104, v105
    v_cvt_pk_bf16_f32 v101, v106, v107
    v_lshlrev_b32 v104, 16, v100
    v_and_b32 v105, 0xffff0000, v100
    v_lshlrev_b32 v106, 16, v101
    v_and_b32 v107, 0xffff0000, v101
    v_lshlrev_b32 v108, 16, v102
    v_and_b32 v109, 0xffff0000, v102
    v_lshlrev_b32 v110, 16, v103
    v_and_b32 v111, 0xffff0000, v103
    v_mul_f32 v104, v104, v108
    v_mul_f32 v105, v105, v109
    v_mul_f32 v106, v106, v110
    v_mul_f32 v107, v107, v111
    v_cvt_pk_bf16_f32 v112, v104, v105
    v_cvt_pk_bf16_f32 v113, v106, v107
    s_mov_b32 s34, 442368
    buffer_store_dwordx2 v[112:113], v1, s[16:19], s34 offen
    v_cvt_pk_bf16_f32 v100, v84, v85
    v_cvt_pk_bf16_f32 v101, v86, v87
    v_cvt_pk_bf16_f32 v102, v92, v93
    v_cvt_pk_bf16_f32 v103, v94, v95
    v_lshlrev_b32 v104, 16, v100
    v_and_b32 v105, 0xffff0000, v100
    v_lshlrev_b32 v106, 16, v101
    v_and_b32 v107, 0xffff0000, v101
    v_mul_f32 v104, 0xbfb8aa3b, v104
    v_mul_f32 v105, 0xbfb8aa3b, v105
    v_mul_f32 v106, 0xbfb8aa3b, v106
    v_mul_f32 v107, 0xbfb8aa3b, v107
    v_exp_f32 v104, v104
    v_exp_f32 v105, v105
    v_exp_f32 v106, v106
    v_exp_f32 v107, v107
    v_add_f32 v104, 1.0, v104
    v_add_f32 v105, 1.0, v105
    v_add_f32 v106, 1.0, v106
    v_add_f32 v107, 1.0, v107
    v_rcp_f32 v104, v104
    v_rcp_f32 v105, v105
    v_rcp_f32 v106, v106
    v_rcp_f32 v107, v107
    s_nop 0
    v_cvt_pk_bf16_f32 v100, v104, v105
    v_cvt_pk_bf16_f32 v101, v106, v107
    v_lshlrev_b32 v104, 16, v100
    v_and_b32 v105, 0xffff0000, v100
    v_lshlrev_b32 v106, 16, v101
    v_and_b32 v107, 0xffff0000, v101
    v_lshlrev_b32 v108, 16, v102
    v_and_b32 v109, 0xffff0000, v102
    v_lshlrev_b32 v110, 16, v103
    v_and_b32 v111, 0xffff0000, v103
    v_mul_f32 v104, v104, v108
    v_mul_f32 v105, v105, v109
    v_mul_f32 v106, v106, v110
    v_mul_f32 v107, v107, v111
    v_cvt_pk_bf16_f32 v112, v104, v105
    v_cvt_pk_bf16_f32 v113, v106, v107
    s_mov_b32 s34, 442400
    buffer_store_dwordx2 v[112:113], v1, s[16:19], s34 offen
    s_waitcnt vmcnt(0)
k1_done:
    s_endpgm
.globl gemm2_kernel
.p2align 8
.type gemm2_kernel,@function
gemm2_kernel:
    s_cmp_ge_u32 s2, 240
    s_cbranch_scc1 k2_done
    s_load_dwordx2 s[4:5], s[0:1], 88
    s_load_dwordx4 s[40:43], s[0:1], 8
    s_load_dwordx2 s[44:45], s[0:1], 64
    v_lshrrev_b32 v1, 6, v0
    v_and_b32 v10, 63, v0
    v_readfirstlane_b32 s32, v1
    v_and_b32 v1, 15, v10
    v_lshlrev_b32 v1, 7, v1
    v_lshrrev_b32 v2, 4, v10
    v_and_b32 v3, 7, v10
    v_xor_b32 v2, v2, v3
    v_lshl_add_u32 v9, v2, 4, v1
    s_lshr_b32 s34, s32, 1
    s_lshl_b32 s34, s34, 13
    v_add_u32 v14, s34, v9
    v_xor_b32 v15, 64, v14
    s_lshl_b32 s30, s32, 12
    s_and_b32 s34, s2, 7
    s_lshr_b32 s35, s2, 3
    s_mul_i32 s36, s35, 21846
    s_lshr_b32 s36, s36, 16
    s_mul_i32 s37, s36, 3
    s_sub_u32 s37, s35, s37
    s_mul_i32 s37, s37, 192
    s_mul_i32 s34, s34, 10
    s_add_u32 s34, s34, s36
    s_and_b32 s36, s34, 15
    s_lshl_b32 s36, s36, 7
    s_lshr_b32 s48, s34, 4
    s_waitcnt lgkmcnt(0)
    s_cmp_ge_u32 s48, 2
    s_cbranch_scc1 k2_dn
    s_cmp_eq_u32 s48, 1
    s_cselect_b32 s6, s42, s40
    s_cselect_b32 s7, s43, s41
    s_mov_b32 s8, s6
    s_mov_b32 s9, s7
    s_and_b32 s9, s9, 0xffff
    s_mov_b32 s10, 0x800000
    s_mov_b32 s11, 0x00020000
    s_mul_i32 s38, s48, 4194304
    s_add_u32 s6, s4, s38
    s_addc_u32 s7, s5, 0
    s_add_u32 s12, s6, 0x400000
    s_addc_u32 s13, s7, 0
    s_and_b32 s13, s13, 0xffff
    s_mov_b32 s14, 0x240000
    s_mov_b32 s15, 0x00020000
    v_lshrrev_b32 v1, 3, v10
    v_and_b32 v2, 7, v10
    v_xor_b32 v2, v2, v1
    v_lshlrev_b32 v2, 4, v2
    s_lshl_b32 s34, s32, 5
    v_add_u32 v3, s34, v1
    s_mov_b32 s34, 4096
    v_mul_lo_u32 v3, s34, v3
    v_add_u32 v11, v3, v2
    s_mul_i32 s34, s36, 4096
    s_add_u32 s20, s34, 0
    s_add_u32 s21, s34, 32768
    s_add_u32 s22, s34, 65536
    s_add_u32 s23, s34, 98304
    s_mul_i32 s38, s32, 48
    s_add_u32 s38, s38, s37
    s_mov_b32 s34, 4096
    v_mul_lo_u32 v3, s34, v1
    v_add_u32 v12, v3, v2
    s_mul_i32 s34, s38, 4096
    s_add_u32 s24, s34, 0
    s_add_u32 s25, s34, 32768
    s_add_u32 s26, s34, 65536
    s_add_u32 s27, s34, 98304
    s_add_u32 s28, s34, 131072
    s_add_u32 s29, s34, 163840
    s_and_b32 s34, s32, 1
    s_mul_i32 s34, s34, 12288
    s_add_u32 s34, s34, 16384
    v_add_u32 v16, s34, v9
    v_xor_b32 v17, 64, v16
    s_mul_i32 s31, s32, 6144
    s_add_u32 s31, s31, 16384
    v_add_u32 v22, 0x14000, v14
    v_add_u32 v23, 0x14000, v15
    v_add_u32 v24, 0x14000, v16
    v_add_u32 v25, 0x14000, v17
    v_add_u32 v26, 0x14000, v18
    v_add_u32 v27, 0x14000, v19
    v_add_u32 v28, 0x14000, v20
    v_add_u32 v29, 0x14000, v21
    v_mov_b32 v32, 0
    v_mov_b32 v33, 0
    v_mov_b32 v34, 0
    v_mov_b32 v35, 0
    v_mov_b32 v36, 0
    v_mov_b32 v37, 0
    v_mov_b32 v38, 0
    v_mov_b32 v39, 0
    v_mov_b32 v40, 0
    v_mov_b32 v41, 0
    v_mov_b32 v42, 0
    v_mov_b32 v43, 0
    v_mov_b32 v44, 0
    v_mov_b32 v45, 0
    v_mov_b32 v46, 0
    v_mov_b32 v47, 0
    v_mov_b32 v48, 0
    v_mov_b32 v49, 0
    v_mov_b32 v50, 0
    v_mov_b32 v51, 0
    v_mov_b32 v52, 0
    v_mov_b32 v53, 0
    v_mov_b32 v54, 0
    v_mov_b32 v55, 0
    v_mov_b32 v56, 0
    v_mov_b32 v57, 0
    v_mov_b32 v58, 0
    v_mov_b32 v59, 0
    v_mov_b32 v60, 0
    v_mov_b32 v61, 0
    v_mov_b32 v62, 0
    v_mov_b32 v63, 0
    v_mov_b32 v64, 0
    v_mov_b32 v65, 0
    v_mov_b32 v66, 0
    v_mov_b32 v67, 0
    v_mov_b32 v68, 0
    v_mov_b32 v69, 0
    v_mov_b32 v70, 0
    v_mov_b32 v71, 0
    v_mov_b32 v72, 0
    v_mov_b32 v73, 0
    v_mov_b32 v74, 0
    v_mov_b32 v75, 0
    v_mov_b32 v76, 0
    v_mov_b32 v77, 0
    v_mov_b32 v78, 0
    v_mov_b32 v79, 0
    v_mov_b32 v80, 0
    v_mov_b32 v81, 0
    v_mov_b32 v82, 0
    v_mov_b32 v83, 0
    v_mov_b32 v84, 0
    v_mov_b32 v85, 0
    v_mov_b32 v86, 0
    v_mov_b32 v87, 0
    v_mov_b32 v88, 0
    v_mov_b32 v89, 0
    v_mov_b32 v90, 0
    v_mov_b32 v91, 0
    v_mov_b32 v92, 0
    v_mov_b32 v93, 0
    v_mov_b32 v94, 0
    v_mov_b32 v95, 0
    v_mov_b32 v96, 0
    v_mov_b32 v97, 0
    v_mov_b32 v98, 0
    v_mov_b32 v99, 0
    v_mov_b32 v100, 0
    v_mov_b32 v101, 0
    v_mov_b32 v102, 0
    v_mov_b32 v103, 0
    v_mov_b32 v104, 0
    v_mov_b32 v105, 0
    v_mov_b32 v106, 0
    v_mov_b32 v107, 0
    v_mov_b32 v108, 0
    v_mov_b32 v109, 0
    v_mov_b32 v110, 0
    v_mov_b32 v111, 0
    v_mov_b32 v112, 0
    v_mov_b32 v113, 0
    v_mov_b32 v114, 0
    v_mov_b32 v115, 0
    v_mov_b32 v116, 0
    v_mov_b32 v117, 0
    v_mov_b32 v118, 0
    v_mov_b32 v119, 0
    v_mov_b32 v120, 0
    v_mov_b32 v121, 0
    v_mov_b32 v122, 0
    v_mov_b32 v123, 0
    v_mov_b32 v124, 0
    v_mov_b32 v125, 0
    v_mov_b32 v126, 0
    v_mov_b32 v127, 0
    s_add_u32 m0, s30, 0
    s_nop 0
    buffer_load_dwordx4 v11, s[8:11], s20 offen lds
    s_add_u32 s20, s20, 128
    s_add_u32 m0, s30, 1024
    s_nop 0
    buffer_load_dwordx4 v11, s[8:11], s21 offen lds
    s_add_u32 s21, s21, 128
    s_add_u32 m0, s30, 2048
    s_nop 0
    buffer_load_dwordx4 v11, s[8:11], s22 offen lds
    s_add_u32 s22, s22, 128
    s_add_u32 m0, s30, 3072
    s_nop 0
    buffer_load_dwordx4 v11, s[8:11], s23 offen lds
    s_add_u32 s23, s23, 128
    s_add_u32 m0, s31, 0
    s_nop 0
    buffer_load_dwordx4 v12, s[12:15], s24 offen lds
    s_add_u32 s24, s24, 128
    s_add_u32 m0, s31, 1024
    s_nop 0
    buffer_load_dwordx4 v12, s[12:15], s25 offen lds
    s_add_u32 s25, s25, 128
    s_add_u32 m0, s31, 2048
    s_nop 0
    buffer_load_dwordx4 v12, s[12:15], s26 offen lds
    s_add_u32 s26, s26, 128
    s_add_u32 m0, s31, 3072
    s_nop 0
    buffer_load_dwordx4 v12, s[12:15], s27 offen lds
    s_add_u32 s27, s27, 128
    s_add_u32 m0, s31, 4096
    s_nop 0
    buffer_load_dwordx4 v12, s[12:15], s28 offen lds
    s_add_u32 s28, s28, 128
    s_add_u32 m0, s31, 5120
    s_nop 0
    buffer_load_dwordx4 v12, s[12:15], s29 offen lds
    s_add_u32 s29, s29, 128
    s_add_u32 m0, s30, 40960
    s_nop 0
    buffer_load_dwordx4 v11, s[8:11], s20 offen lds
    s_add_u32 s20, s20, 128
    s_add_u32 m0, s30, 41984
    s_nop 0
    buffer_load_dwordx4 v11, s[8:11], s21 offen lds
    s_add_u32 s21, s21, 128
    s_add_u32 m0, s30, 43008
    s_nop 0
    buffer_load_dwordx4 v11, s[8:11], s22 offen lds
    s_add_u32 s22, s22, 128
    s_add_u32 m0, s30, 44032
    s_nop 0
    buffer_load_dwordx4 v11, s[8:11], s23 offen lds
    s_add_u32 s23, s23, 128
    s_add_u32 m0, s31, 40960
    s_nop 0
    buffer_load_dwordx4 v12, s[12:15], s24 offen lds
    s_add_u32 s24, s24, 128
    s_add_u32 m0, s31, 41984
    s_nop 0
    buffer_load_dwordx4 v12, s[12:15], s25 offen lds
    s_add_u32 s25, s25, 128
    s_add_u32 m0, s31, 43008
    s_nop 0
    buffer_load_dwordx4 v12, s[12:15], s26 offen lds
    s_add_u32 s26, s26, 128
    s_add_u32 m0, s31, 44032
    s_nop 0
    buffer_load_dwordx4 v12, s[12:15], s27 offen lds
    s_add_u32 s27, s27, 128
    s_add_u32 m0, s31, 45056
    s_nop 0
    buffer_load_dwordx4 v12, s[12:15], s28 offen lds
    s_add_u32 s28, s28, 128
    s_add_u32 m0, s31, 46080
    s_nop 0
    buffer_load_dwordx4 v12, s[12:15], s29 offen lds
    s_add_u32 s29, s29, 128
    s_add_u32 m0, s30, 81920
    s_nop 0
    buffer_load_dwordx4 v11, s[8:11], s20 offen lds
    s_add_u32 s20, s20, 128
    s_add_u32 m0, s30, 82944
    s_nop 0
    buffer_load_dwordx4 v11, s[8:11], s21 offen lds
    s_add_u32 s21, s21, 128
    s_add_u32 m0, s30, 83968
    s_nop 0
    buffer_load_dwordx4 v11, s[8:11], s22 offen lds
    s_add_u32 s22, s22, 128
    s_add_u32 m0, s30, 84992
    s_nop 0
    buffer_load_dwordx4 v11, s[8:11], s23 offen lds
    s_add_u32 s23, s23, 128
    s_add_u32 m0, s31, 81920
    s_nop 0
    buffer_load_dwordx4 v12, s[12:15], s24 offen lds
    s_add_u32 s24, s24, 128
    s_add_u32 m0, s31, 82944
    s_nop 0
    buffer_load_dwordx4 v12, s[12:15], s25 offen lds
    s_add_u32 s25, s25, 128
    s_add_u32 m0, s31, 83968
    s_nop 0
    buffer_load_dwordx4 v12, s[12:15], s26 offen lds
    s_add_u32 s26, s26, 128
    s_add_u32 m0, s31, 84992
    s_nop 0
    buffer_load_dwordx4 v12, s[12:15], s27 offen lds
    s_add_u32 s27, s27, 128
    s_add_u32 m0, s31, 86016
    s_nop 0
    buffer_load_dwordx4 v12, s[12:15], s28 offen lds
    s_add_u32 s28, s28, 128
    s_add_u32 m0, s31, 87040
    s_nop 0
    buffer_load_dwordx4 v12, s[12:15], s29 offen lds
    s_add_u32 s29, s29, 128
    s_mov_b32 s33, 0
kloop_3:
    s_waitcnt vmcnt(20)
    s_barrier
    ds_read_b128 v[128:131], v14 offset:0
    ds_read_b128 v[132:135], v14 offset:2048
    ds_read_b128 v[136:139], v14 offset:4096
    ds_read_b128 v[140:143], v14 offset:6144
    ds_read_b128 v[144:147], v16 offset:0
    ds_read_b128 v[148:151], v16 offset:2048
    ds_read_b128 v[152:155], v16 offset:4096
    ds_read_b128 v[156:159], v16 offset:6144
    ds_read_b128 v[160:163], v16 offset:8192
    ds_read_b128 v[164:167], v16 offset:10240
    ds_read_b128 v[168:171], v15 offset:0
    ds_read_b128 v[172:175], v15 offset:2048
    ds_read_b128 v[176:179], v15 offset:4096
    ds_read_b128 v[180:183], v15 offset:6144
    ds_read_b128 v[184:187], v17 offset:0
    ds_read_b128 v[188:191], v17 offset:2048
    ds_read_b128 v[192:195], v17 offset:4096
    ds_read_b128 v[196:199], v17 offset:6144
    ds_read_b128 v[200:203], v17 offset:8192
    ds_read_b128 v[204:207], v17 offset:10240
    s_add_u32 m0, s30, 122880
    s_nop 0
    buffer_load_dwordx4 v11, s[8:11], s20 offen lds
    s_add_u32 s20, s20, 128
    s_add_u32 m0, s30, 123904
    s_nop 0
    buffer_load_dwordx4 v11, s[8:11], s21 offen lds
    s_add_u32 s21, s21, 128
    s_waitcnt lgkmcnt(10)
    v_mfma_f32_16x16x32_bf16 v[32:35], v[144:147], v[128:131], v[32:35]
    v_mfma_f32_16x16x32_bf16 v[36:39], v[148:151], v[128:131], v[36:39]
    v_mfma_f32_16x16x32_bf16 v[40:43], v[152:155], v[128:131], v[40:43]
    v_mfma_f32_16x16x32_bf16 v[44:47], v[156:159], v[128:131], v[44:47]
    v_mfma_f32_16x16x32_bf16 v[48:51], v[160:163], v[128:131], v[48:51]
    s_add_u32 m0, s30, 124928
    s_nop 0
    buffer_load_dwordx4 v11, s[8:11], s22 offen lds
    s_add_u32 s22, s22, 128
    v_mfma_f32_16x16x32_bf16 v[52:55], v[164:167], v[128:131], v[52:55]
    v_mfma_f32_16x16x32_bf16 v[56:59], v[144:147], v[132:135], v[56:59]
    v_mfma_f32_16x16x32_bf16 v[60:63], v[148:151], v[132:135], v[60:63]
    v_mfma_f32_16x16x32_bf16 v[64:67], v[152:155], v[132:135], v[64:67]
    v_mfma_f32_16x16x32_bf16 v[68:71], v[156:159], v[132:135], v[68:71]
    s_add_u32 m0, s30, 125952
    s_nop 0
    buffer_load_dwordx4 v11, s[8:11], s23 offen lds
    s_add_u32 s23, s23, 128
    v_mfma_f32_16x16x32_bf16 v[72:75], v[160:163], v[132:135], v[72:75]
    v_mfma_f32_16x16x32_bf16 v[76:79], v[164:167], v[132:135], v[76:79]
    v_mfma_f32_16x16x32_bf16 v[80:83], v[144:147], v[136:139], v[80:83]
    v_mfma_f32_16x16x32_bf16 v[84:87], v[148:151], v[136:139], v[84:87]
    v_mfma_f32_16x16x32_bf16 v[88:91], v[152:155], v[136:139], v[88:91]
    s_add_u32 m0, s31, 122880
    s_nop 0
    buffer_load_dwordx4 v12, s[12:15], s24 offen lds
    s_add_u32 s24, s24, 128
    v_mfma_f32_16x16x32_bf16 v[92:95], v[156:159], v[136:139], v[92:95]
    v_mfma_f32_16x16x32_bf16 v[96:99], v[160:163], v[136:139], v[96:99]
    v_mfma_f32_16x16x32_bf16 v[100:103], v[164:167], v[136:139], v[100:103]
    v_mfma_f32_16x16x32_bf16 v[104:107], v[144:147], v[140:143], v[104:107]
    v_mfma_f32_16x16x32_bf16 v[108:111], v[148:151], v[140:143], v[108:111]
    s_add_u32 m0, s31, 123904
    s_nop 0
    buffer_load_dwordx4 v12, s[12:15], s25 offen lds
    s_add_u32 s25, s25, 128
    v_mfma_f32_16x16x32_bf16 v[112:115], v[152:155], v[140:143], v[112:115]
    v_mfma_f32_16x16x32_bf16 v[116:119], v[156:159], v[140:143], v[116:119]
    v_mfma_f32_16x16x32_bf16 v[120:123], v[160:163], v[140:143], v[120:123]
    v_mfma_f32_16x16x32_bf16 v[124:127], v[164:167], v[140:143], v[124:127]
    s_waitcnt lgkmcnt(0)
    v_mfma_f32_16x16x32_bf16 v[32:35], v[184:187], v[168:171], v[32:35]
    s_add_u32 m0, s31, 124928
    s_nop 0
    buffer_load_dwordx4 v12, s[12:15], s26 offen lds
    s_add_u32 s26, s26, 128
    v_mfma_f32_16x16x32_bf16 v[36:39], v[188:191], v[168:171], v[36:39]
    v_mfma_f32_16x16x32_bf16 v[40:43], v[192:195], v[168:171], v[40:43]
    v_mfma_f32_16x16x32_bf16 v[44:47], v[196:199], v[168:171], v[44:47]
    v_mfma_f32_16x16x32_bf16 v[48:51], v[200:203], v[168:171], v[48:51]
    v_mfma_f32_16x16x32_bf16 v[52:55], v[204:207], v[168:171], v[52:55]
    s_add_u32 m0, s31, 125952
    s_nop 0
    buffer_load_dwordx4 v12, s[12:15], s27 offen lds
    s_add_u32 s27, s27, 128
    v_mfma_f32_16x16x32_bf16 v[56:59], v[184:187], v[172:175], v[56:59]
    v_mfma_f32_16x16x32_bf16 v[60:63], v[188:191], v[172:175], v[60:63]
    v_mfma_f32_16x16x32_bf16 v[64:67], v[192:195], v[172:175], v[64:67]
    v_mfma_f32_16x16x32_bf16 v[68:71], v[196:199], v[172:175], v[68:71]
    v_mfma_f32_16x16x32_bf16 v[72:75], v[200:203], v[172:175], v[72:75]
    s_add_u32 m0, s31, 126976
    s_nop 0
    buffer_load_dwordx4 v12, s[12:15], s28 offen lds
    s_add_u32 s28, s28, 128
    v_mfma_f32_16x16x32_bf16 v[76:79], v[204:207], v[172:175], v[76:79]
    v_mfma_f32_16x16x32_bf16 v[80:83], v[184:187], v[176:179], v[80:83]
    v_mfma_f32_16x16x32_bf16 v[84:87], v[188:191], v[176:179], v[84:87]
    v_mfma_f32_16x16x32_bf16 v[88:91], v[192:195], v[176:179], v[88:91]
    v_mfma_f32_16x16x32_bf16 v[92:95], v[196:199], v[176:179], v[92:95]
    s_add_u32 m0, s31, 128000
    s_nop 0
    buffer_load_dwordx4 v12, s[12:15], s29 offen lds
    s_add_u32 s29, s29, 128
    v_mfma_f32_16x16x32_bf16 v[96:99], v[200:203], v[176:179], v[96:99]
    v_mfma_f32_16x16x32_bf16 v[100:103], v[204:207], v[176:179], v[100:103]
    v_mfma_f32_16x16x32_bf16 v[104:107], v[184:187], v[180:183], v[104:107]
    v_mfma_f32_16x16x32_bf16 v[108:111], v[188:191], v[180:183], v[108:111]
    v_mfma_f32_16x16x32_bf16 v[112:115], v[192:195], v[180:183], v[112:115]
    v_mfma_f32_16x16x32_bf16 v[116:119], v[196:199], v[180:183], v[116:119]
    v_mfma_f32_16x16x32_bf16 v[120:123], v[200:203], v[180:183], v[120:123]
    v_mfma_f32_16x16x32_bf16 v[124:127], v[204:207], v[180:183], v[124:127]
    s_waitcnt vmcnt(20)
    s_barrier
    ds_read_b128 v[128:131], v14 offset:40960
    ds_read_b128 v[132:135], v14 offset:43008
    ds_read_b128 v[136:139], v14 offset:45056
    ds_read_b128 v[140:143], v14 offset:47104
    ds_read_b128 v[144:147], v16 offset:40960
    ds_read_b128 v[148:151], v16 offset:43008
    ds_read_b128 v[152:155], v16 offset:45056
    ds_read_b128 v[156:159], v16 offset:47104
    ds_read_b128 v[160:163], v16 offset:49152
    ds_read_b128 v[164:167], v16 offset:51200
    ds_read_b128 v[168:171], v15 offset:40960
    ds_read_b128 v[172:175], v15 offset:43008
    ds_read_b128 v[176:179], v15 offset:45056
    ds_read_b128 v[180:183], v15 offset:47104
    ds_read_b128 v[184:187], v17 offset:40960
    ds_read_b128 v[188:191], v17 offset:43008
    ds_read_b128 v[192:195], v17 offset:45056
    ds_read_b128 v[196:199], v17 offset:47104
    ds_read_b128 v[200:203], v17 offset:49152
    ds_read_b128 v[204:207], v17 offset:51200
    s_add_u32 m0, s30, 0
    s_nop 0
    buffer_load_dwordx4 v11, s[8:11], s20 offen lds
    s_add_u32 s20, s20, 128
    s_add_u32 m0, s30, 1024
    s_nop 0
    buffer_load_dwordx4 v11, s[8:11], s21 offen lds
    s_add_u32 s21, s21, 128
    s_waitcnt lgkmcnt(10)
    v_mfma_f32_16x16x32_bf16 v[32:35], v[144:147], v[128:131], v[32:35]
    v_mfma_f32_16x16x32_bf16 v[36:39], v[148:151], v[128:131], v[36:39]
    v_mfma_f32_16x16x32_bf16 v[40:43], v[152:155], v[128:131], v[40:43]
    v_mfma_f32_16x16x32_bf16 v[44:47], v[156:159], v[128:131], v[44:47]
    v_mfma_f32_16x16x32_bf16 v[48:51], v[160:163], v[128:131], v[48:51]
    s_add_u32 m0, s30, 2048
    s_nop 0
    buffer_load_dwordx4 v11, s[8:11], s22 offen lds
    s_add_u32 s22, s22, 128
    v_mfma_f32_16x16x32_bf16 v[52:55], v[164:167], v[128:131], v[52:55]
    v_mfma_f32_16x16x32_bf16 v[56:59], v[144:147], v[132:135], v[56:59]
    v_mfma_f32_16x16x32_bf16 v[60:63], v[148:151], v[132:135], v[60:63]
    v_mfma_f32_16x16x32_bf16 v[64:67], v[152:155], v[132:135], v[64:67]
    v_mfma_f32_16x16x32_bf16 v[68:71], v[156:159], v[132:135], v[68:71]
    s_add_u32 m0, s30, 3072
    s_nop 0
    buffer_load_dwordx4 v11, s[8:11], s23 offen lds
    s_add_u32 s23, s23, 128
    v_mfma_f32_16x16x32_bf16 v[72:75], v[160:163], v[132:135], v[72:75]
    v_mfma_f32_16x16x32_bf16 v[76:79], v[164:167], v[132:135], v[76:79]
    v_mfma_f32_16x16x32_bf16 v[80:83], v[144:147], v[136:139], v[80:83]
    v_mfma_f32_16x16x32_bf16 v[84:87], v[148:151], v[136:139], v[84:87]
    v_mfma_f32_16x16x32_bf16 v[88:91], v[152:155], v[136:139], v[88:91]
    s_add_u32 m0, s31, 0
    s_nop 0
    buffer_load_dwordx4 v12, s[12:15], s24 offen lds
    s_add_u32 s24, s24, 128
    v_mfma_f32_16x16x32_bf16 v[92:95], v[156:159], v[136:139], v[92:95]
    v_mfma_f32_16x16x32_bf16 v[96:99], v[160:163], v[136:139], v[96:99]
    v_mfma_f32_16x16x32_bf16 v[100:103], v[164:167], v[136:139], v[100:103]
    v_mfma_f32_16x16x32_bf16 v[104:107], v[144:147], v[140:143], v[104:107]
    v_mfma_f32_16x16x32_bf16 v[108:111], v[148:151], v[140:143], v[108:111]
    s_add_u32 m0, s31, 1024
    s_nop 0
    buffer_load_dwordx4 v12, s[12:15], s25 offen lds
    s_add_u32 s25, s25, 128
    v_mfma_f32_16x16x32_bf16 v[112:115], v[152:155], v[140:143], v[112:115]
    v_mfma_f32_16x16x32_bf16 v[116:119], v[156:159], v[140:143], v[116:119]
    v_mfma_f32_16x16x32_bf16 v[120:123], v[160:163], v[140:143], v[120:123]
    v_mfma_f32_16x16x32_bf16 v[124:127], v[164:167], v[140:143], v[124:127]
    s_waitcnt lgkmcnt(0)
    v_mfma_f32_16x16x32_bf16 v[32:35], v[184:187], v[168:171], v[32:35]
    s_add_u32 m0, s31, 2048
    s_nop 0
    buffer_load_dwordx4 v12, s[12:15], s26 offen lds
    s_add_u32 s26, s26, 128
    v_mfma_f32_16x16x32_bf16 v[36:39], v[188:191], v[168:171], v[36:39]
    v_mfma_f32_16x16x32_bf16 v[40:43], v[192:195], v[168:171], v[40:43]
    v_mfma_f32_16x16x32_bf16 v[44:47], v[196:199], v[168:171], v[44:47]
    v_mfma_f32_16x16x32_bf16 v[48:51], v[200:203], v[168:171], v[48:51]
    v_mfma_f32_16x16x32_bf16 v[52:55], v[204:207], v[168:171], v[52:55]
    s_add_u32 m0, s31, 3072
    s_nop 0
    buffer_load_dwordx4 v12, s[12:15], s27 offen lds
    s_add_u32 s27, s27, 128
    v_mfma_f32_16x16x32_bf16 v[56:59], v[184:187], v[172:175], v[56:59]
    v_mfma_f32_16x16x32_bf16 v[60:63], v[188:191], v[172:175], v[60:63]
    v_mfma_f32_16x16x32_bf16 v[64:67], v[192:195], v[172:175], v[64:67]
    v_mfma_f32_16x16x32_bf16 v[68:71], v[196:199], v[172:175], v[68:71]
    v_mfma_f32_16x16x32_bf16 v[72:75], v[200:203], v[172:175], v[72:75]
    s_add_u32 m0, s31, 4096
    s_nop 0
    buffer_load_dwordx4 v12, s[12:15], s28 offen lds
    s_add_u32 s28, s28, 128
    v_mfma_f32_16x16x32_bf16 v[76:79], v[204:207], v[172:175], v[76:79]
    v_mfma_f32_16x16x32_bf16 v[80:83], v[184:187], v[176:179], v[80:83]
    v_mfma_f32_16x16x32_bf16 v[84:87], v[188:191], v[176:179], v[84:87]
    v_mfma_f32_16x16x32_bf16 v[88:91], v[192:195], v[176:179], v[88:91]
    v_mfma_f32_16x16x32_bf16 v[92:95], v[196:199], v[176:179], v[92:95]
    s_add_u32 m0, s31, 5120
    s_nop 0
    buffer_load_dwordx4 v12, s[12:15], s29 offen lds
    s_add_u32 s29, s29, 128
    v_mfma_f32_16x16x32_bf16 v[96:99], v[200:203], v[176:179], v[96:99]
    v_mfma_f32_16x16x32_bf16 v[100:103], v[204:207], v[176:179], v[100:103]
    v_mfma_f32_16x16x32_bf16 v[104:107], v[184:187], v[180:183], v[104:107]
    v_mfma_f32_16x16x32_bf16 v[108:111], v[188:191], v[180:183], v[108:111]
    v_mfma_f32_16x16x32_bf16 v[112:115], v[192:195], v[180:183], v[112:115]
    v_mfma_f32_16x16x32_bf16 v[116:119], v[196:199], v[180:183], v[116:119]
    v_mfma_f32_16x16x32_bf16 v[120:123], v[200:203], v[180:183], v[120:123]
    v_mfma_f32_16x16x32_bf16 v[124:127], v[204:207], v[180:183], v[124:127]
    s_waitcnt vmcnt(20)
    s_barrier
    ds_read_b128 v[128:131], v22 offset:0
    ds_read_b128 v[132:135], v22 offset:2048
    ds_read_b128 v[136:139], v22 offset:4096
    ds_read_b128 v[140:143], v22 offset:6144
    ds_read_b128 v[144:147], v24 offset:0
    ds_read_b128 v[148:151], v24 offset:2048
    ds_read_b128 v[152:155], v24 offset:4096
    ds_read_b128 v[156:159], v24 offset:6144
    ds_read_b128 v[160:163], v24 offset:8192
    ds_read_b128 v[164:167], v24 offset:10240
    ds_read_b128 v[168:171], v23 offset:0
    ds_read_b128 v[172:175], v23 offset:2048
    ds_read_b128 v[176:179], v23 offset:4096
    ds_read_b128 v[180:183], v23 offset:6144
    ds_read_b128 v[184:187], v25 offset:0
    ds_read_b128 v[188:191], v25 offset:2048
    ds_read_b128 v[192:195], v25 offset:4096
    ds_read_b128 v[196:199], v25 offset:6144
    ds_read_b128 v[200:203], v25 offset:8192
    ds_read_b128 v[204:207], v25 offset:10240
    s_add_u32 m0, s30, 40960
    s_nop 0
    buffer_load_dwordx4 v11, s[8:11], s20 offen lds
    s_add_u32 s20, s20, 128
    s_add_u32 m0, s30, 41984
    s_nop 0
    buffer_load_dwordx4 v11, s[8:11], s21 offen lds
    s_add_u32 s21, s21, 128
    s_waitcnt lgkmcnt(10)
    v_mfma_f32_16x16x32_bf16 v[32:35], v[144:147], v[128:131], v[32:35]
    v_mfma_f32_16x16x32_bf16 v[36:39], v[148:151], v[128:131], v[36:39]
    v_mfma_f32_16x16x32_bf16 v[40:43], v[152:155], v[128:131], v[40:43]
    v_mfma_f32_16x16x32_bf16 v[44:47], v[156:159], v[128:131], v[44:47]
    v_mfma_f32_16x16x32_bf16 v[48:51], v[160:163], v[128:131], v[48:51]
    s_add_u32 m0, s30, 43008
    s_nop 0
    buffer_load_dwordx4 v11, s[8:11], s22 offen lds
    s_add_u32 s22, s22, 128
    v_mfma_f32_16x16x32_bf16 v[52:55], v[164:167], v[128:131], v[52:55]
    v_mfma_f32_16x16x32_bf16 v[56:59], v[144:147], v[132:135], v[56:59]
    v_mfma_f32_16x16x32_bf16 v[60:63], v[148:151], v[132:135], v[60:63]
    v_mfma_f32_16x16x32_bf16 v[64:67], v[152:155], v[132:135], v[64:67]
    v_mfma_f32_16x16x32_bf16 v[68:71], v[156:159], v[132:135], v[68:71]
    s_add_u32 m0, s30, 44032
    s_nop 0
    buffer_load_dwordx4 v11, s[8:11], s23 offen lds
    s_add_u32 s23, s23, 128
    v_mfma_f32_16x16x32_bf16 v[72:75], v[160:163], v[132:135], v[72:75]
    v_mfma_f32_16x16x32_bf16 v[76:79], v[164:167], v[132:135], v[76:79]
    v_mfma_f32_16x16x32_bf16 v[80:83], v[144:147], v[136:139], v[80:83]
    v_mfma_f32_16x16x32_bf16 v[84:87], v[148:151], v[136:139], v[84:87]
    v_mfma_f32_16x16x32_bf16 v[88:91], v[152:155], v[136:139], v[88:91]
    s_add_u32 m0, s31, 40960
    s_nop 0
    buffer_load_dwordx4 v12, s[12:15], s24 offen lds
    s_add_u32 s24, s24, 128
    v_mfma_f32_16x16x32_bf16 v[92:95], v[156:159], v[136:139], v[92:95]
    v_mfma_f32_16x16x32_bf16 v[96:99], v[160:163], v[136:139], v[96:99]
    v_mfma_f32_16x16x32_bf16 v[100:103], v[164:167], v[136:139], v[100:103]
    v_mfma_f32_16x16x32_bf16 v[104:107], v[144:147], v[140:143], v[104:107]
    v_mfma_f32_16x16x32_bf16 v[108:111], v[148:151], v[140:143], v[108:111]
    s_add_u32 m0, s31, 41984
    s_nop 0
    buffer_load_dwordx4 v12, s[12:15], s25 offen lds
    s_add_u32 s25, s25, 128
    v_mfma_f32_16x16x32_bf16 v[112:115], v[152:155], v[140:143], v[112:115]
    v_mfma_f32_16x16x32_bf16 v[116:119], v[156:159], v[140:143], v[116:119]
    v_mfma_f32_16x16x32_bf16 v[120:123], v[160:163], v[140:143], v[120:123]
    v_mfma_f32_16x16x32_bf16 v[124:127], v[164:167], v[140:143], v[124:127]
    s_waitcnt lgkmcnt(0)
    v_mfma_f32_16x16x32_bf16 v[32:35], v[184:187], v[168:171], v[32:35]
    s_add_u32 m0, s31, 43008
    s_nop 0
    buffer_load_dwordx4 v12, s[12:15], s26 offen lds
    s_add_u32 s26, s26, 128
    v_mfma_f32_16x16x32_bf16 v[36:39], v[188:191], v[168:171], v[36:39]
    v_mfma_f32_16x16x32_bf16 v[40:43], v[192:195], v[168:171], v[40:43]
    v_mfma_f32_16x16x32_bf16 v[44:47], v[196:199], v[168:171], v[44:47]
    v_mfma_f32_16x16x32_bf16 v[48:51], v[200:203], v[168:171], v[48:51]
    v_mfma_f32_16x16x32_bf16 v[52:55], v[204:207], v[168:171], v[52:55]
    s_add_u32 m0, s31, 44032
    s_nop 0
    buffer_load_dwordx4 v12, s[12:15], s27 offen lds
    s_add_u32 s27, s27, 128
    v_mfma_f32_16x16x32_bf16 v[56:59], v[184:187], v[172:175], v[56:59]
    v_mfma_f32_16x16x32_bf16 v[60:63], v[188:191], v[172:175], v[60:63]
    v_mfma_f32_16x16x32_bf16 v[64:67], v[192:195], v[172:175], v[64:67]
    v_mfma_f32_16x16x32_bf16 v[68:71], v[196:199], v[172:175], v[68:71]
    v_mfma_f32_16x16x32_bf16 v[72:75], v[200:203], v[172:175], v[72:75]
    s_add_u32 m0, s31, 45056
    s_nop 0
    buffer_load_dwordx4 v12, s[12:15], s28 offen lds
    s_add_u32 s28, s28, 128
    v_mfma_f32_16x16x32_bf16 v[76:79], v[204:207], v[172:175], v[76:79]
    v_mfma_f32_16x16x32_bf16 v[80:83], v[184:187], v[176:179], v[80:83]
    v_mfma_f32_16x16x32_bf16 v[84:87], v[188:191], v[176:179], v[84:87]
    v_mfma_f32_16x16x32_bf16 v[88:91], v[192:195], v[176:179], v[88:91]
    v_mfma_f32_16x16x32_bf16 v[92:95], v[196:199], v[176:179], v[92:95]
    s_add_u32 m0, s31, 46080
    s_nop 0
    buffer_load_dwordx4 v12, s[12:15], s29 offen lds
    s_add_u32 s29, s29, 128
    v_mfma_f32_16x16x32_bf16 v[96:99], v[200:203], v[176:179], v[96:99]
    v_mfma_f32_16x16x32_bf16 v[100:103], v[204:207], v[176:179], v[100:103]
    v_mfma_f32_16x16x32_bf16 v[104:107], v[184:187], v[180:183], v[104:107]
    v_mfma_f32_16x16x32_bf16 v[108:111], v[188:191], v[180:183], v[108:111]
    v_mfma_f32_16x16x32_bf16 v[112:115], v[192:195], v[180:183], v[112:115]
    v_mfma_f32_16x16x32_bf16 v[116:119], v[196:199], v[180:183], v[116:119]
    v_mfma_f32_16x16x32_bf16 v[120:123], v[200:203], v[180:183], v[120:123]
    v_mfma_f32_16x16x32_bf16 v[124:127], v[204:207], v[180:183], v[124:127]
    s_waitcnt vmcnt(20)
    s_barrier
    ds_read_b128 v[128:131], v22 offset:40960
    ds_read_b128 v[132:135], v22 offset:43008
    ds_read_b128 v[136:139], v22 offset:45056
    ds_read_b128 v[140:143], v22 offset:47104
    ds_read_b128 v[144:147], v24 offset:40960
    ds_read_b128 v[148:151], v24 offset:43008
    ds_read_b128 v[152:155], v24 offset:45056
    ds_read_b128 v[156:159], v24 offset:47104
    ds_read_b128 v[160:163], v24 offset:49152
    ds_read_b128 v[164:167], v24 offset:51200
    ds_read_b128 v[168:171], v23 offset:40960
    ds_read_b128 v[172:175], v23 offset:43008
    ds_read_b128 v[176:179], v23 offset:45056
    ds_read_b128 v[180:183], v23 offset:47104
    ds_read_b128 v[184:187], v25 offset:40960
    ds_read_b128 v[188:191], v25 offset:43008
    ds_read_b128 v[192:195], v25 offset:45056
    ds_read_b128 v[196:199], v25 offset:47104
    ds_read_b128 v[200:203], v25 offset:49152
    ds_read_b128 v[204:207], v25 offset:51200
    s_add_u32 m0, s30, 81920
    s_nop 0
    buffer_load_dwordx4 v11, s[8:11], s20 offen lds
    s_add_u32 s20, s20, 128
    s_add_u32 m0, s30, 82944
    s_nop 0
    buffer_load_dwordx4 v11, s[8:11], s21 offen lds
    s_add_u32 s21, s21, 128
    s_waitcnt lgkmcnt(10)
    v_mfma_f32_16x16x32_bf16 v[32:35], v[144:147], v[128:131], v[32:35]
    v_mfma_f32_16x16x32_bf16 v[36:39], v[148:151], v[128:131], v[36:39]
    v_mfma_f32_16x16x32_bf16 v[40:43], v[152:155], v[128:131], v[40:43]
    v_mfma_f32_16x16x32_bf16 v[44:47], v[156:159], v[128:131], v[44:47]
    v_mfma_f32_16x16x32_bf16 v[48:51], v[160:163], v[128:131], v[48:51]
    s_add_u32 m0, s30, 83968
    s_nop 0
    buffer_load_dwordx4 v11, s[8:11], s22 offen lds
    s_add_u32 s22, s22, 128
    v_mfma_f32_16x16x32_bf16 v[52:55], v[164:167], v[128:131], v[52:55]
    v_mfma_f32_16x16x32_bf16 v[56:59], v[144:147], v[132:135], v[56:59]
    v_mfma_f32_16x16x32_bf16 v[60:63], v[148:151], v[132:135], v[60:63]
    v_mfma_f32_16x16x32_bf16 v[64:67], v[152:155], v[132:135], v[64:67]
    v_mfma_f32_16x16x32_bf16 v[68:71], v[156:159], v[132:135], v[68:71]
    s_add_u32 m0, s30, 84992
    s_nop 0
    buffer_load_dwordx4 v11, s[8:11], s23 offen lds
    s_add_u32 s23, s23, 128
    v_mfma_f32_16x16x32_bf16 v[72:75], v[160:163], v[132:135], v[72:75]
    v_mfma_f32_16x16x32_bf16 v[76:79], v[164:167], v[132:135], v[76:79]
    v_mfma_f32_16x16x32_bf16 v[80:83], v[144:147], v[136:139], v[80:83]
    v_mfma_f32_16x16x32_bf16 v[84:87], v[148:151], v[136:139], v[84:87]
    v_mfma_f32_16x16x32_bf16 v[88:91], v[152:155], v[136:139], v[88:91]
    s_add_u32 m0, s31, 81920
    s_nop 0
    buffer_load_dwordx4 v12, s[12:15], s24 offen lds
    s_add_u32 s24, s24, 128
    v_mfma_f32_16x16x32_bf16 v[92:95], v[156:159], v[136:139], v[92:95]
    v_mfma_f32_16x16x32_bf16 v[96:99], v[160:163], v[136:139], v[96:99]
    v_mfma_f32_16x16x32_bf16 v[100:103], v[164:167], v[136:139], v[100:103]
    v_mfma_f32_16x16x32_bf16 v[104:107], v[144:147], v[140:143], v[104:107]
    v_mfma_f32_16x16x32_bf16 v[108:111], v[148:151], v[140:143], v[108:111]
    s_add_u32 m0, s31, 82944
    s_nop 0
    buffer_load_dwordx4 v12, s[12:15], s25 offen lds
    s_add_u32 s25, s25, 128
    v_mfma_f32_16x16x32_bf16 v[112:115], v[152:155], v[140:143], v[112:115]
    v_mfma_f32_16x16x32_bf16 v[116:119], v[156:159], v[140:143], v[116:119]
    v_mfma_f32_16x16x32_bf16 v[120:123], v[160:163], v[140:143], v[120:123]
    v_mfma_f32_16x16x32_bf16 v[124:127], v[164:167], v[140:143], v[124:127]
    s_waitcnt lgkmcnt(0)
    v_mfma_f32_16x16x32_bf16 v[32:35], v[184:187], v[168:171], v[32:35]
    s_add_u32 m0, s31, 83968
    s_nop 0
    buffer_load_dwordx4 v12, s[12:15], s26 offen lds
    s_add_u32 s26, s26, 128
    v_mfma_f32_16x16x32_bf16 v[36:39], v[188:191], v[168:171], v[36:39]
    v_mfma_f32_16x16x32_bf16 v[40:43], v[192:195], v[168:171], v[40:43]
    v_mfma_f32_16x16x32_bf16 v[44:47], v[196:199], v[168:171], v[44:47]
    v_mfma_f32_16x16x32_bf16 v[48:51], v[200:203], v[168:171], v[48:51]
    v_mfma_f32_16x16x32_bf16 v[52:55], v[204:207], v[168:171], v[52:55]
    s_add_u32 m0, s31, 84992
    s_nop 0
    buffer_load_dwordx4 v12, s[12:15], s27 offen lds
    s_add_u32 s27, s27, 128
    v_mfma_f32_16x16x32_bf16 v[56:59], v[184:187], v[172:175], v[56:59]
    v_mfma_f32_16x16x32_bf16 v[60:63], v[188:191], v[172:175], v[60:63]
    v_mfma_f32_16x16x32_bf16 v[64:67], v[192:195], v[172:175], v[64:67]
    v_mfma_f32_16x16x32_bf16 v[68:71], v[196:199], v[172:175], v[68:71]
    v_mfma_f32_16x16x32_bf16 v[72:75], v[200:203], v[172:175], v[72:75]
    s_add_u32 m0, s31, 86016
    s_nop 0
    buffer_load_dwordx4 v12, s[12:15], s28 offen lds
    s_add_u32 s28, s28, 128
    v_mfma_f32_16x16x32_bf16 v[76:79], v[204:207], v[172:175], v[76:79]
    v_mfma_f32_16x16x32_bf16 v[80:83], v[184:187], v[176:179], v[80:83]
    v_mfma_f32_16x16x32_bf16 v[84:87], v[188:191], v[176:179], v[84:87]
    v_mfma_f32_16x16x32_bf16 v[88:91], v[192:195], v[176:179], v[88:91]
    v_mfma_f32_16x16x32_bf16 v[92:95], v[196:199], v[176:179], v[92:95]
    s_add_u32 m0, s31, 87040
    s_nop 0
    buffer_load_dwordx4 v12, s[12:15], s29 offen lds
    s_add_u32 s29, s29, 128
    v_mfma_f32_16x16x32_bf16 v[96:99], v[200:203], v[176:179], v[96:99]
    v_mfma_f32_16x16x32_bf16 v[100:103], v[204:207], v[176:179], v[100:103]
    v_mfma_f32_16x16x32_bf16 v[104:107], v[184:187], v[180:183], v[104:107]
    v_mfma_f32_16x16x32_bf16 v[108:111], v[188:191], v[180:183], v[108:111]
    v_mfma_f32_16x16x32_bf16 v[112:115], v[192:195], v[180:183], v[112:115]
    v_mfma_f32_16x16x32_bf16 v[116:119], v[196:199], v[180:183], v[116:119]
    v_mfma_f32_16x16x32_bf16 v[120:123], v[200:203], v[180:183], v[120:123]
    v_mfma_f32_16x16x32_bf16 v[124:127], v[204:207], v[180:183], v[124:127]
    s_add_u32 s33, s33, 1
    s_cmp_lt_u32 s33, 7
    s_cbranch_scc1 kloop_3
    s_waitcnt vmcnt(20)
    s_barrier
    ds_read_b128 v[128:131], v14 offset:0
    ds_read_b128 v[132:135], v14 offset:2048
    ds_read_b128 v[136:139], v14 offset:4096
    ds_read_b128 v[140:143], v14 offset:6144
    ds_read_b128 v[144:147], v16 offset:0
    ds_read_b128 v[148:151], v16 offset:2048
    ds_read_b128 v[152:155], v16 offset:4096
    ds_read_b128 v[156:159], v16 offset:6144
    ds_read_b128 v[160:163], v16 offset:8192
    ds_read_b128 v[164:167], v16 offset:10240
    ds_read_b128 v[168:171], v15 offset:0
    ds_read_b128 v[172:175], v15 offset:2048
    ds_read_b128 v[176:179], v15 offset:4096
    ds_read_b128 v[180:183], v15 offset:6144
    ds_read_b128 v[184:187], v17 offset:0
    ds_read_b128 v[188:191], v17 offset:2048
    ds_read_b128 v[192:195], v17 offset:4096
    ds_read_b128 v[196:199], v17 offset:6144
    ds_read_b128 v[200:203], v17 offset:8192
    ds_read_b128 v[204:207], v17 offset:10240
    s_add_u32 m0, s30, 122880
    s_nop 0
    buffer_load_dwordx4 v11, s[8:11], s20 offen lds
    s_add_u32 s20, s20, 128
    s_add_u32 m0, s30, 123904
    s_nop 0
    buffer_load_dwordx4 v11, s[8:11], s21 offen lds
    s_add_u32 s21, s21, 128
    s_waitcnt lgkmcnt(10)
    v_mfma_f32_16x16x32_bf16 v[32:35], v[144:147], v[128:131], v[32:35]
    v_mfma_f32_16x16x32_bf16 v[36:39], v[148:151], v[128:131], v[36:39]
    v_mfma_f32_16x16x32_bf16 v[40:43], v[152:155], v[128:131], v[40:43]
    v_mfma_f32_16x16x32_bf16 v[44:47], v[156:159], v[128:131], v[44:47]
    v_mfma_f32_16x16x32_bf16 v[48:51], v[160:163], v[128:131], v[48:51]
    s_add_u32 m0, s30, 124928
    s_nop 0
    buffer_load_dwordx4 v11, s[8:11], s22 offen lds
    s_add_u32 s22, s22, 128
    v_mfma_f32_16x16x32_bf16 v[52:55], v[164:167], v[128:131], v[52:55]
    v_mfma_f32_16x16x32_bf16 v[56:59], v[144:147], v[132:135], v[56:59]
    v_mfma_f32_16x16x32_bf16 v[60:63], v[148:151], v[132:135], v[60:63]
    v_mfma_f32_16x16x32_bf16 v[64:67], v[152:155], v[132:135], v[64:67]
    v_mfma_f32_16x16x32_bf16 v[68:71], v[156:159], v[132:135], v[68:71]
    s_add_u32 m0, s30, 125952
    s_nop 0
    buffer_load_dwordx4 v11, s[8:11], s23 offen lds
    s_add_u32 s23, s23, 128
    v_mfma_f32_16x16x32_bf16 v[72:75], v[160:163], v[132:135], v[72:75]
    v_mfma_f32_16x16x32_bf16 v[76:79], v[164:167], v[132:135], v[76:79]
    v_mfma_f32_16x16x32_bf16 v[80:83], v[144:147], v[136:139], v[80:83]
    v_mfma_f32_16x16x32_bf16 v[84:87], v[148:151], v[136:139], v[84:87]
    v_mfma_f32_16x16x32_bf16 v[88:91], v[152:155], v[136:139], v[88:91]
    s_add_u32 m0, s31, 122880
    s_nop 0
    buffer_load_dwordx4 v12, s[12:15], s24 offen lds
    s_add_u32 s24, s24, 128
    v_mfma_f32_16x16x32_bf16 v[92:95], v[156:159], v[136:139], v[92:95]
    v_mfma_f32_16x16x32_bf16 v[96:99], v[160:163], v[136:139], v[96:99]
    v_mfma_f32_16x16x32_bf16 v[100:103], v[164:167], v[136:139], v[100:103]
    v_mfma_f32_16x16x32_bf16 v[104:107], v[144:147], v[140:143], v[104:107]
    v_mfma_f32_16x16x32_bf16 v[108:111], v[148:151], v[140:143], v[108:111]
    s_add_u32 m0, s31, 123904
    s_nop 0
    buffer_load_dwordx4 v12, s[12:15], s25 offen lds
    s_add_u32 s25, s25, 128
    v_mfma_f32_16x16x32_bf16 v[112:115], v[152:155], v[140:143], v[112:115]
    v_mfma_f32_16x16x32_bf16 v[116:119], v[156:159], v[140:143], v[116:119]
    v_mfma_f32_16x16x32_bf16 v[120:123], v[160:163], v[140:143], v[120:123]
    v_mfma_f32_16x16x32_bf16 v[124:127], v[164:167], v[140:143], v[124:127]
    s_waitcnt lgkmcnt(0)
    v_mfma_f32_16x16x32_bf16 v[32:35], v[184:187], v[168:171], v[32:35]
    s_add_u32 m0, s31, 124928
    s_nop 0
    buffer_load_dwordx4 v12, s[12:15], s26 offen lds
    s_add_u32 s26, s26, 128
    v_mfma_f32_16x16x32_bf16 v[36:39], v[188:191], v[168:171], v[36:39]
    v_mfma_f32_16x16x32_bf16 v[40:43], v[192:195], v[168:171], v[40:43]
    v_mfma_f32_16x16x32_bf16 v[44:47], v[196:199], v[168:171], v[44:47]
    v_mfma_f32_16x16x32_bf16 v[48:51], v[200:203], v[168:171], v[48:51]
    v_mfma_f32_16x16x32_bf16 v[52:55], v[204:207], v[168:171], v[52:55]
    s_add_u32 m0, s31, 125952
    s_nop 0
    buffer_load_dwordx4 v12, s[12:15], s27 offen lds
    s_add_u32 s27, s27, 128
    v_mfma_f32_16x16x32_bf16 v[56:59], v[184:187], v[172:175], v[56:59]
    v_mfma_f32_16x16x32_bf16 v[60:63], v[188:191], v[172:175], v[60:63]
    v_mfma_f32_16x16x32_bf16 v[64:67], v[192:195], v[172:175], v[64:67]
    v_mfma_f32_16x16x32_bf16 v[68:71], v[196:199], v[172:175], v[68:71]
    v_mfma_f32_16x16x32_bf16 v[72:75], v[200:203], v[172:175], v[72:75]
    s_add_u32 m0, s31, 126976
    s_nop 0
    buffer_load_dwordx4 v12, s[12:15], s28 offen lds
    s_add_u32 s28, s28, 128
    v_mfma_f32_16x16x32_bf16 v[76:79], v[204:207], v[172:175], v[76:79]
    v_mfma_f32_16x16x32_bf16 v[80:83], v[184:187], v[176:179], v[80:83]
    v_mfma_f32_16x16x32_bf16 v[84:87], v[188:191], v[176:179], v[84:87]
    v_mfma_f32_16x16x32_bf16 v[88:91], v[192:195], v[176:179], v[88:91]
    v_mfma_f32_16x16x32_bf16 v[92:95], v[196:199], v[176:179], v[92:95]
    s_add_u32 m0, s31, 128000
    s_nop 0
    buffer_load_dwordx4 v12, s[12:15], s29 offen lds
    s_add_u32 s29, s29, 128
    v_mfma_f32_16x16x32_bf16 v[96:99], v[200:203], v[176:179], v[96:99]
    v_mfma_f32_16x16x32_bf16 v[100:103], v[204:207], v[176:179], v[100:103]
    v_mfma_f32_16x16x32_bf16 v[104:107], v[184:187], v[180:183], v[104:107]
    v_mfma_f32_16x16x32_bf16 v[108:111], v[188:191], v[180:183], v[108:111]
    v_mfma_f32_16x16x32_bf16 v[112:115], v[192:195], v[180:183], v[112:115]
    v_mfma_f32_16x16x32_bf16 v[116:119], v[196:199], v[180:183], v[116:119]
    v_mfma_f32_16x16x32_bf16 v[120:123], v[200:203], v[180:183], v[120:123]
    v_mfma_f32_16x16x32_bf16 v[124:127], v[204:207], v[180:183], v[124:127]
    s_waitcnt vmcnt(20)
    s_barrier
    ds_read_b128 v[128:131], v14 offset:40960
    ds_read_b128 v[132:135], v14 offset:43008
    ds_read_b128 v[136:139], v14 offset:45056
    ds_read_b128 v[140:143], v14 offset:47104
    ds_read_b128 v[144:147], v16 offset:40960
    ds_read_b128 v[148:151], v16 offset:43008
    ds_read_b128 v[152:155], v16 offset:45056
    ds_read_b128 v[156:159], v16 offset:47104
    ds_read_b128 v[160:163], v16 offset:49152
    ds_read_b128 v[164:167], v16 offset:51200
    ds_read_b128 v[168:171], v15 offset:40960
    ds_read_b128 v[172:175], v15 offset:43008
    ds_read_b128 v[176:179], v15 offset:45056
    ds_read_b128 v[180:183], v15 offset:47104
    ds_read_b128 v[184:187], v17 offset:40960
    ds_read_b128 v[188:191], v17 offset:43008
    ds_read_b128 v[192:195], v17 offset:45056
    ds_read_b128 v[196:199], v17 offset:47104
    ds_read_b128 v[200:203], v17 offset:49152
    ds_read_b128 v[204:207], v17 offset:51200
    s_waitcnt lgkmcnt(10)
    v_mfma_f32_16x16x32_bf16 v[32:35], v[144:147], v[128:131], v[32:35]
    v_mfma_f32_16x16x32_bf16 v[36:39], v[148:151], v[128:131], v[36:39]
    v_mfma_f32_16x16x32_bf16 v[40:43], v[152:155], v[128:131], v[40:43]
    v_mfma_f32_16x16x32_bf16 v[44:47], v[156:159], v[128:131], v[44:47]
    v_mfma_f32_16x16x32_bf16 v[48:51], v[160:163], v[128:131], v[48:51]
    v_mfma_f32_16x16x32_bf16 v[52:55], v[164:167], v[128:131], v[52:55]
    v_mfma_f32_16x16x32_bf16 v[56:59], v[144:147], v[132:135], v[56:59]
    v_mfma_f32_16x16x32_bf16 v[60:63], v[148:151], v[132:135], v[60:63]
    v_mfma_f32_16x16x32_bf16 v[64:67], v[152:155], v[132:135], v[64:67]
    v_mfma_f32_16x16x32_bf16 v[68:71], v[156:159], v[132:135], v[68:71]
    v_mfma_f32_16x16x32_bf16 v[72:75], v[160:163], v[132:135], v[72:75]
    v_mfma_f32_16x16x32_bf16 v[76:79], v[164:167], v[132:135], v[76:79]
    v_mfma_f32_16x16x32_bf16 v[80:83], v[144:147], v[136:139], v[80:83]
    v_mfma_f32_16x16x32_bf16 v[84:87], v[148:151], v[136:139], v[84:87]
    v_mfma_f32_16x16x32_bf16 v[88:91], v[152:155], v[136:139], v[88:91]
    v_mfma_f32_16x16x32_bf16 v[92:95], v[156:159], v[136:139], v[92:95]
    v_mfma_f32_16x16x32_bf16 v[96:99], v[160:163], v[136:139], v[96:99]
    v_mfma_f32_16x16x32_bf16 v[100:103], v[164:167], v[136:139], v[100:103]
    v_mfma_f32_16x16x32_bf16 v[104:107], v[144:147], v[140:143], v[104:107]
    v_mfma_f32_16x16x32_bf16 v[108:111], v[148:151], v[140:143], v[108:111]
    v_mfma_f32_16x16x32_bf16 v[112:115], v[152:155], v[140:143], v[112:115]
    v_mfma_f32_16x16x32_bf16 v[116:119], v[156:159], v[140:143], v[116:119]
    v_mfma_f32_16x16x32_bf16 v[120:123], v[160:163], v[140:143], v[120:123]
    v_mfma_f32_16x16x32_bf16 v[124:127], v[164:167], v[140:143], v[124:127]
    s_waitcnt lgkmcnt(0)
    v_mfma_f32_16x16x32_bf16 v[32:35], v[184:187], v[168:171], v[32:35]
    v_mfma_f32_16x16x32_bf16 v[36:39], v[188:191], v[168:171], v[36:39]
    v_mfma_f32_16x16x32_bf16 v[40:43], v[192:195], v[168:171], v[40:43]
    v_mfma_f32_16x16x32_bf16 v[44:47], v[196:199], v[168:171], v[44:47]
    v_mfma_f32_16x16x32_bf16 v[48:51], v[200:203], v[168:171], v[48:51]
    v_mfma_f32_16x16x32_bf16 v[52:55], v[204:207], v[168:171], v[52:55]
    v_mfma_f32_16x16x32_bf16 v[56:59], v[184:187], v[172:175], v[56:59]
    v_mfma_f32_16x16x32_bf16 v[60:63], v[188:191], v[172:175], v[60:63]
    v_mfma_f32_16x16x32_bf16 v[64:67], v[192:195], v[172:175], v[64:67]
    v_mfma_f32_16x16x32_bf16 v[68:71], v[196:199], v[172:175], v[68:71]
    v_mfma_f32_16x16x32_bf16 v[72:75], v[200:203], v[172:175], v[72:75]
    v_mfma_f32_16x16x32_bf16 v[76:79], v[204:207], v[172:175], v[76:79]
    v_mfma_f32_16x16x32_bf16 v[80:83], v[184:187], v[176:179], v[80:83]
    v_mfma_f32_16x16x32_bf16 v[84:87], v[188:191], v[176:179], v[84:87]
    v_mfma_f32_16x16x32_bf16 v[88:91], v[192:195], v[176:179], v[88:91]
    v_mfma_f32_16x16x32_bf16 v[92:95], v[196:199], v[176:179], v[92:95]
    v_mfma_f32_16x16x32_bf16 v[96:99], v[200:203], v[176:179], v[96:99]
    v_mfma_f32_16x16x32_bf16 v[100:103], v[204:207], v[176:179], v[100:103]
    v_mfma_f32_16x16x32_bf16 v[104:107], v[184:187], v[180:183], v[104:107]
    v_mfma_f32_16x16x32_bf16 v[108:111], v[188:191], v[180:183], v[108:111]
    v_mfma_f32_16x16x32_bf16 v[112:115], v[192:195], v[180:183], v[112:115]
    v_mfma_f32_16x16x32_bf16 v[116:119], v[196:199], v[180:183], v[116:119]
    v_mfma_f32_16x16x32_bf16 v[120:123], v[200:203], v[180:183], v[120:123]
    v_mfma_f32_16x16x32_bf16 v[124:127], v[204:207], v[180:183], v[124:127]
    s_waitcnt vmcnt(10)
    s_barrier
    ds_read_b128 v[128:131], v22 offset:0
    ds_read_b128 v[132:135], v22 offset:2048
    ds_read_b128 v[136:139], v22 offset:4096
    ds_read_b128 v[140:143], v22 offset:6144
    ds_read_b128 v[144:147], v24 offset:0
    ds_read_b128 v[148:151], v24 offset:2048
    ds_read_b128 v[152:155], v24 offset:4096
    ds_read_b128 v[156:159], v24 offset:6144
    ds_read_b128 v[160:163], v24 offset:8192
    ds_read_b128 v[164:167], v24 offset:10240
    ds_read_b128 v[168:171], v23 offset:0
    ds_read_b128 v[172:175], v23 offset:2048
    ds_read_b128 v[176:179], v23 offset:4096
    ds_read_b128 v[180:183], v23 offset:6144
    ds_read_b128 v[184:187], v25 offset:0
    ds_read_b128 v[188:191], v25 offset:2048
    ds_read_b128 v[192:195], v25 offset:4096
    ds_read_b128 v[196:199], v25 offset:6144
    ds_read_b128 v[200:203], v25 offset:8192
    ds_read_b128 v[204:207], v25 offset:10240
    s_waitcnt lgkmcnt(10)
    v_mfma_f32_16x16x32_bf16 v[32:35], v[144:147], v[128:131], v[32:35]
    v_mfma_f32_16x16x32_bf16 v[36:39], v[148:151], v[128:131], v[36:39]
    v_mfma_f32_16x16x32_bf16 v[40:43], v[152:155], v[128:131], v[40:43]
    v_mfma_f32_16x16x32_bf16 v[44:47], v[156:159], v[128:131], v[44:47]
    v_mfma_f32_16x16x32_bf16 v[48:51], v[160:163], v[128:131], v[48:51]
    v_mfma_f32_16x16x32_bf16 v[52:55], v[164:167], v[128:131], v[52:55]
    v_mfma_f32_16x16x32_bf16 v[56:59], v[144:147], v[132:135], v[56:59]
    v_mfma_f32_16x16x32_bf16 v[60:63], v[148:151], v[132:135], v[60:63]
    v_mfma_f32_16x16x32_bf16 v[64:67], v[152:155], v[132:135], v[64:67]
    v_mfma_f32_16x16x32_bf16 v[68:71], v[156:159], v[132:135], v[68:71]
    v_mfma_f32_16x16x32_bf16 v[72:75], v[160:163], v[132:135], v[72:75]
    v_mfma_f32_16x16x32_bf16 v[76:79], v[164:167], v[132:135], v[76:79]
    v_mfma_f32_16x16x32_bf16 v[80:83], v[144:147], v[136:139], v[80:83]
    v_mfma_f32_16x16x32_bf16 v[84:87], v[148:151], v[136:139], v[84:87]
    v_mfma_f32_16x16x32_bf16 v[88:91], v[152:155], v[136:139], v[88:91]
    v_mfma_f32_16x16x32_bf16 v[92:95], v[156:159], v[136:139], v[92:95]
    v_mfma_f32_16x16x32_bf16 v[96:99], v[160:163], v[136:139], v[96:99]
    v_mfma_f32_16x16x32_bf16 v[100:103], v[164:167], v[136:139], v[100:103]
    v_mfma_f32_16x16x32_bf16 v[104:107], v[144:147], v[140:143], v[104:107]
    v_mfma_f32_16x16x32_bf16 v[108:111], v[148:151], v[140:143], v[108:111]
    v_mfma_f32_16x16x32_bf16 v[112:115], v[152:155], v[140:143], v[112:115]
    v_mfma_f32_16x16x32_bf16 v[116:119], v[156:159], v[140:143], v[116:119]
    v_mfma_f32_16x16x32_bf16 v[120:123], v[160:163], v[140:143], v[120:123]
    v_mfma_f32_16x16x32_bf16 v[124:127], v[164:167], v[140:143], v[124:127]
    s_waitcnt lgkmcnt(0)
    v_mfma_f32_16x16x32_bf16 v[32:35], v[184:187], v[168:171], v[32:35]
    v_mfma_f32_16x16x32_bf16 v[36:39], v[188:191], v[168:171], v[36:39]
    v_mfma_f32_16x16x32_bf16 v[40:43], v[192:195], v[168:171], v[40:43]
    v_mfma_f32_16x16x32_bf16 v[44:47], v[196:199], v[168:171], v[44:47]
    v_mfma_f32_16x16x32_bf16 v[48:51], v[200:203], v[168:171], v[48:51]
    v_mfma_f32_16x16x32_bf16 v[52:55], v[204:207], v[168:171], v[52:55]
    v_mfma_f32_16x16x32_bf16 v[56:59], v[184:187], v[172:175], v[56:59]
    v_mfma_f32_16x16x32_bf16 v[60:63], v[188:191], v[172:175], v[60:63]
    v_mfma_f32_16x16x32_bf16 v[64:67], v[192:195], v[172:175], v[64:67]
    v_mfma_f32_16x16x32_bf16 v[68:71], v[196:199], v[172:175], v[68:71]
    v_mfma_f32_16x16x32_bf16 v[72:75], v[200:203], v[172:175], v[72:75]
    v_mfma_f32_16x16x32_bf16 v[76:79], v[204:207], v[172:175], v[76:79]
    v_mfma_f32_16x16x32_bf16 v[80:83], v[184:187], v[176:179], v[80:83]
    v_mfma_f32_16x16x32_bf16 v[84:87], v[188:191], v[176:179], v[84:87]
    v_mfma_f32_16x16x32_bf16 v[88:91], v[192:195], v[176:179], v[88:91]
    v_mfma_f32_16x16x32_bf16 v[92:95], v[196:199], v[176:179], v[92:95]
    v_mfma_f32_16x16x32_bf16 v[96:99], v[200:203], v[176:179], v[96:99]
    v_mfma_f32_16x16x32_bf16 v[100:103], v[204:207], v[176:179], v[100:103]
    v_mfma_f32_16x16x32_bf16 v[104:107], v[184:187], v[180:183], v[104:107]
    v_mfma_f32_16x16x32_bf16 v[108:111], v[188:191], v[180:183], v[108:111]
    v_mfma_f32_16x16x32_bf16 v[112:115], v[192:195], v[180:183], v[112:115]
    v_mfma_f32_16x16x32_bf16 v[116:119], v[196:199], v[180:183], v[116:119]
    v_mfma_f32_16x16x32_bf16 v[120:123], v[200:203], v[180:183], v[120:123]
    v_mfma_f32_16x16x32_bf16 v[124:127], v[204:207], v[180:183], v[124:127]
    s_waitcnt vmcnt(0)
    s_barrier
    ds_read_b128 v[128:131], v22 offset:40960
    ds_read_b128 v[132:135], v22 offset:43008
    ds_read_b128 v[136:139], v22 offset:45056
    ds_read_b128 v[140:143], v22 offset:47104
    ds_read_b128 v[144:147], v24 offset:40960
    ds_read_b128 v[148:151], v24 offset:43008
    ds_read_b128 v[152:155], v24 offset:45056
    ds_read_b128 v[156:159], v24 offset:47104
    ds_read_b128 v[160:163], v24 offset:49152
    ds_read_b128 v[164:167], v24 offset:51200
    ds_read_b128 v[168:171], v23 offset:40960
    ds_read_b128 v[172:175], v23 offset:43008
    ds_read_b128 v[176:179], v23 offset:45056
    ds_read_b128 v[180:183], v23 offset:47104
    ds_read_b128 v[184:187], v25 offset:40960
    ds_read_b128 v[188:191], v25 offset:43008
    ds_read_b128 v[192:195], v25 offset:45056
    ds_read_b128 v[196:199], v25 offset:47104
    ds_read_b128 v[200:203], v25 offset:49152
    ds_read_b128 v[204:207], v25 offset:51200
    s_waitcnt lgkmcnt(10)
    v_mfma_f32_16x16x32_bf16 v[32:35], v[144:147], v[128:131], v[32:35]
    v_mfma_f32_16x16x32_bf16 v[36:39], v[148:151], v[128:131], v[36:39]
    v_mfma_f32_16x16x32_bf16 v[40:43], v[152:155], v[128:131], v[40:43]
    v_mfma_f32_16x16x32_bf16 v[44:47], v[156:159], v[128:131], v[44:47]
    v_mfma_f32_16x16x32_bf16 v[48:51], v[160:163], v[128:131], v[48:51]
    v_mfma_f32_16x16x32_bf16 v[52:55], v[164:167], v[128:131], v[52:55]
    v_mfma_f32_16x16x32_bf16 v[56:59], v[144:147], v[132:135], v[56:59]
    v_mfma_f32_16x16x32_bf16 v[60:63], v[148:151], v[132:135], v[60:63]
    v_mfma_f32_16x16x32_bf16 v[64:67], v[152:155], v[132:135], v[64:67]
    v_mfma_f32_16x16x32_bf16 v[68:71], v[156:159], v[132:135], v[68:71]
    v_mfma_f32_16x16x32_bf16 v[72:75], v[160:163], v[132:135], v[72:75]
    v_mfma_f32_16x16x32_bf16 v[76:79], v[164:167], v[132:135], v[76:79]
    v_mfma_f32_16x16x32_bf16 v[80:83], v[144:147], v[136:139], v[80:83]
    v_mfma_f32_16x16x32_bf16 v[84:87], v[148:151], v[136:139], v[84:87]
    v_mfma_f32_16x16x32_bf16 v[88:91], v[152:155], v[136:139], v[88:91]
    v_mfma_f32_16x16x32_bf16 v[92:95], v[156:159], v[136:139], v[92:95]
    v_mfma_f32_16x16x32_bf16 v[96:99], v[160:163], v[136:139], v[96:99]
    v_mfma_f32_16x16x32_bf16 v[100:103], v[164:167], v[136:139], v[100:103]
    v_mfma_f32_16x16x32_bf16 v[104:107], v[144:147], v[140:143], v[104:107]
    v_mfma_f32_16x16x32_bf16 v[108:111], v[148:151], v[140:143], v[108:111]
    v_mfma_f32_16x16x32_bf16 v[112:115], v[152:155], v[140:143], v[112:115]
    v_mfma_f32_16x16x32_bf16 v[116:119], v[156:159], v[140:143], v[116:119]
    v_mfma_f32_16x16x32_bf16 v[120:123], v[160:163], v[140:143], v[120:123]
    v_mfma_f32_16x16x32_bf16 v[124:127], v[164:167], v[140:143], v[124:127]
    s_waitcnt lgkmcnt(0)
    v_mfma_f32_16x16x32_bf16 v[32:35], v[184:187], v[168:171], v[32:35]
    v_mfma_f32_16x16x32_bf16 v[36:39], v[188:191], v[168:171], v[36:39]
    v_mfma_f32_16x16x32_bf16 v[40:43], v[192:195], v[168:171], v[40:43]
    v_mfma_f32_16x16x32_bf16 v[44:47], v[196:199], v[168:171], v[44:47]
    v_mfma_f32_16x16x32_bf16 v[48:51], v[200:203], v[168:171], v[48:51]
    v_mfma_f32_16x16x32_bf16 v[52:55], v[204:207], v[168:171], v[52:55]
    v_mfma_f32_16x16x32_bf16 v[56:59], v[184:187], v[172:175], v[56:59]
    v_mfma_f32_16x16x32_bf16 v[60:63], v[188:191], v[172:175], v[60:63]
    v_mfma_f32_16x16x32_bf16 v[64:67], v[192:195], v[172:175], v[64:67]
    v_mfma_f32_16x16x32_bf16 v[68:71], v[196:199], v[172:175], v[68:71]
    v_mfma_f32_16x16x32_bf16 v[72:75], v[200:203], v[172:175], v[72:75]
    v_mfma_f32_16x16x32_bf16 v[76:79], v[204:207], v[172:175], v[76:79]
    v_mfma_f32_16x16x32_bf16 v[80:83], v[184:187], v[176:179], v[80:83]
    v_mfma_f32_16x16x32_bf16 v[84:87], v[188:191], v[176:179], v[84:87]
    v_mfma_f32_16x16x32_bf16 v[88:91], v[192:195], v[176:179], v[88:91]
    v_mfma_f32_16x16x32_bf16 v[92:95], v[196:199], v[176:179], v[92:95]
    v_mfma_f32_16x16x32_bf16 v[96:99], v[200:203], v[176:179], v[96:99]
    v_mfma_f32_16x16x32_bf16 v[100:103], v[204:207], v[176:179], v[100:103]
    v_mfma_f32_16x16x32_bf16 v[104:107], v[184:187], v[180:183], v[104:107]
    v_mfma_f32_16x16x32_bf16 v[108:111], v[188:191], v[180:183], v[108:111]
    v_mfma_f32_16x16x32_bf16 v[112:115], v[192:195], v[180:183], v[112:115]
    v_mfma_f32_16x16x32_bf16 v[116:119], v[196:199], v[180:183], v[116:119]
    v_mfma_f32_16x16x32_bf16 v[120:123], v[200:203], v[180:183], v[120:123]
    v_mfma_f32_16x16x32_bf16 v[124:127], v[204:207], v[180:183], v[124:127]
    s_nop 7
    s_nop 7
    s_branch k2_store
k2_dn:
    s_add_u32 s8, s4, 0x1000000
    s_addc_u32 s9, s5, 0
    s_and_b32 s9, s9, 0xffff
    s_mov_b32 s10, 0x1200000
    s_mov_b32 s11, 0x00020000
    s_mov_b32 s12, s44
    s_mov_b32 s13, s45
    s_and_b32 s13, s13, 0xffff
    s_mov_b32 s14, 0x510000
    s_mov_b32 s15, 0x00020000
    s_sub_u32 s49, s48, 2
    s_mul_i32 s49, s49, 1536
    v_lshrrev_b32 v1, 3, v10
    v_and_b32 v2, 7, v10
    v_xor_b32 v2, v2, v1
    v_lshlrev_b32 v2, 4, v2
    s_lshl_b32 s34, s32, 5
    v_add_u32 v3, s34, v1
    s_mov_b32 s34, 9216
    v_mul_lo_u32 v3, s34, v3
    v_add_u32 v11, v3, v2
    s_mul_i32 s34, s36, 9216
    s_add_u32 s20, s34, 0
    s_add_u32 s21, s34, 73728
    s_add_u32 s22, s34, 147456
    s_add_u32 s23, s34, 221184
    s_lshl_b32 s38, s49, 1
    s_add_u32 s20, s20, s38
    s_add_u32 s21, s21, s38
    s_add_u32 s22, s22, s38
    s_add_u32 s23, s23, s38
    v_lshrrev_b32 v1, 3, v10
    s_mov_b32 s34, 1152
    v_mul_lo_u32 v3, s34, v1
    v_and_b32 v4, 2, v1
    v_and_b32 v5, 7, v10
    v_xor_b32 v5, v5, v4
    v_lshl_add_u32 v12, v5, 4, v3
    v_xor_b32 v13, 64, v12
    v_and_b32 v4, 15, v10
    v_lshrrev_b32 v5, 4, v10
    v_lshrrev_b32 v6, 2, v4
    v_lshl_add_u32 v7, v5, 3, v6
    v_lshlrev_b32 v7, 7, v7
    v_and_b32 v6, 2, v6
    v_and_b32 v5, 1, v5
    v_lshl_or_b32 v6, v5, 2, v6
    v_bfe_u32 v5, v4, 1, 1
    v_xor_b32 v5, v5, v6
    v_lshl_add_u32 v7, v5, 4, v7
    v_and_b32 v5, 1, v4
    v_lshl_add_u32 v8, v5, 3, v7
    v_add_u32 v8, 0x4000, v8
    s_mul_i32 s31, s32, 6144
    s_add_u32 s31, s31, 16384
    s_mul_i32 s38, s32, 6
    s_add_u32 s38, s38, 0
    s_lshr_b32 s39, s38, 3
    s_and_b32 s38, s38, 7
    s_lshl_b32 s38, s38, 3
    s_add_u32 s38, s38, s49
    s_mul_i32 s38, s38, 1152
    s_lshl_b32 s39, s39, 6
    s_add_u32 s39, s39, s37
    s_lshl_b32 s39, s39, 1
    s_add_u32 s24, s38, s39
    s_mul_i32 s38, s32, 6
    s_add_u32 s38, s38, 1
    s_lshr_b32 s39, s38, 3
    s_and_b32 s38, s38, 7
    s_lshl_b32 s38, s38, 3
    s_add_u32 s38, s38, s49
    s_mul_i32 s38, s38, 1152
    s_lshl_b32 s39, s39, 6
    s_add_u32 s39, s39, s37
    s_lshl_b32 s39, s39, 1
    s_add_u32 s25, s38, s39
    s_mul_i32 s38, s32, 6
    s_add_u32 s38, s38, 2
    s_lshr_b32 s39, s38, 3
    s_and_b32 s38, s38, 7
    s_lshl_b32 s38, s38, 3
    s_add_u32 s38, s38, s49
    s_mul_i32 s38, s38, 1152
    s_lshl_b32 s39, s39, 6
    s_add_u32 s39, s39, s37
    s_lshl_b32 s39, s39, 1
    s_add_u32 s26, s38, s39
    s_mul_i32 s38, s32, 6
    s_add_u32 s38, s38, 3
    s_lshr_b32 s39, s38, 3
    s_and_b32 s38, s38, 7
    s_lshl_b32 s38, s38, 3
    s_add_u32 s38, s38, s49
    s_mul_i32 s38, s38, 1152
    s_lshl_b32 s39, s39, 6
    s_add_u32 s39, s39, s37
    s_lshl_b32 s39, s39, 1
    s_add_u32 s27, s38, s39
    s_mul_i32 s38, s32, 6
    s_add_u32 s38, s38, 4
    s_lshr_b32 s39, s38, 3
    s_and_b32 s38, s38, 7
    s_lshl_b32 s38, s38, 3
    s_add_u32 s38, s38, s49
    s_mul_i32 s38, s38, 1152
    s_lshl_b32 s39, s39, 6
    s_add_u32 s39, s39, s37
    s_lshl_b32 s39, s39, 1
    s_add_u32 s28, s38, s39
    s_mul_i32 s38, s32, 6
    s_add_u32 s38, s38, 5
    s_lshr_b32 s39, s38, 3
    s_and_b32 s38, s38, 7
    s_lshl_b32 s38, s38, 3
    s_add_u32 s38, s38, s49
    s_mul_i32 s38, s38, 1152
    s_lshl_b32 s39, s39, 6
    s_add_u32 s39, s39, s37
    s_lshl_b32 s39, s39, 1
    s_add_u32 s29, s38, s39
    s_and_b32 s38, s32, 1
    s_mul_i32 s38, s38, 96
    s_add_u32 s38, s38, 0
    s_lshr_b32 s39, s38, 6
    s_lshl_b32 s39, s39, 13
    s_and_b32 s38, s38, 63
    s_lshl_b32 s38, s38, 1
    v_xor_b32 v16, s38, v8
    v_add_u32 v16, s39, v16
    s_and_b32 s38, s32, 1
    s_mul_i32 s38, s38, 96
    s_add_u32 s38, s38, 16
    s_lshr_b32 s39, s38, 6
    s_lshl_b32 s39, s39, 13
    s_and_b32 s38, s38, 63
    s_lshl_b32 s38, s38, 1
    v_xor_b32 v17, s38, v8
    v_add_u32 v17, s39, v17
    s_and_b32 s38, s32, 1
    s_mul_i32 s38, s38, 96
    s_add_u32 s38, s38, 32
    s_lshr_b32 s39, s38, 6
    s_lshl_b32 s39, s39, 13
    s_and_b32 s38, s38, 63
    s_lshl_b32 s38, s38, 1
    v_xor_b32 v18, s38, v8
    v_add_u32 v18, s39, v18
    s_and_b32 s38, s32, 1
    s_mul_i32 s38, s38, 96
    s_add_u32 s38, s38, 48
    s_lshr_b32 s39, s38, 6
    s_lshl_b32 s39, s39, 13
    s_and_b32 s38, s38, 63
    s_lshl_b32 s38, s38, 1
    v_xor_b32 v19, s38, v8
    v_add_u32 v19, s39, v19
    s_and_b32 s38, s32, 1
    s_mul_i32 s38, s38, 96
    s_add_u32 s38, s38, 64
    s_lshr_b32 s39, s38, 6
    s_lshl_b32 s39, s39, 13
    s_and_b32 s38, s38, 63
    s_lshl_b32 s38, s38, 1
    v_xor_b32 v20, s38, v8
    v_add_u32 v20, s39, v20
    s_and_b32 s38, s32, 1
    s_mul_i32 s38, s38, 96
    s_add_u32 s38, s38, 80
    s_lshr_b32 s39, s38, 6
    s_lshl_b32 s39, s39, 13
    s_and_b32 s38, s38, 63
    s_lshl_b32 s38, s38, 1
    v_xor_b32 v21, s38, v8
    v_add_u32 v21, s39, v21
    v_add_u32 v22, 0x14000, v14
    v_add_u32 v23, 0x14000, v15
    v_add_u32 v24, 0x14000, v16
    v_add_u32 v25, 0x14000, v17
    v_add_u32 v26, 0x14000, v18
    v_add_u32 v27, 0x14000, v19
    v_add_u32 v28, 0x14000, v20
    v_add_u32 v29, 0x14000, v21
    v_mov_b32 v32, 0
    v_mov_b32 v33, 0
    v_mov_b32 v34, 0
    v_mov_b32 v35, 0
    v_mov_b32 v36, 0
    v_mov_b32 v37, 0
    v_mov_b32 v38, 0
    v_mov_b32 v39, 0
    v_mov_b32 v40, 0
    v_mov_b32 v41, 0
    v_mov_b32 v42, 0
    v_mov_b32 v43, 0
    v_mov_b32 v44, 0
    v_mov_b32 v45, 0
    v_mov_b32 v46, 0
    v_mov_b32 v47, 0
    v_mov_b32 v48, 0
    v_mov_b32 v49, 0
    v_mov_b32 v50, 0
    v_mov_b32 v51, 0
    v_mov_b32 v52, 0
    v_mov_b32 v53, 0
    v_mov_b32 v54, 0
    v_mov_b32 v55, 0
    v_mov_b32 v56, 0
    v_mov_b32 v57, 0
    v_mov_b32 v58, 0
    v_mov_b32 v59, 0
    v_mov_b32 v60, 0
    v_mov_b32 v61, 0
    v_mov_b32 v62, 0
    v_mov_b32 v63, 0
    v_mov_b32 v64, 0
    v_mov_b32 v65, 0
    v_mov_b32 v66, 0
    v_mov_b32 v67, 0
    v_mov_b32 v68, 0
    v_mov_b32 v69, 0
    v_mov_b32 v70, 0
    v_mov_b32 v71, 0
    v_mov_b32 v72, 0
    v_mov_b32 v73, 0
    v_mov_b32 v74, 0
    v_mov_b32 v75, 0
    v_mov_b32 v76, 0
    v_mov_b32 v77, 0
    v_mov_b32 v78, 0
    v_mov_b32 v79, 0
    v_mov_b32 v80, 0
    v_mov_b32 v81, 0
    v_mov_b32 v82, 0
    v_mov_b32 v83, 0
    v_mov_b32 v84, 0
    v_mov_b32 v85, 0
    v_mov_b32 v86, 0
    v_mov_b32 v87, 0
    v_mov_b32 v88, 0
    v_mov_b32 v89, 0
    v_mov_b32 v90, 0
    v_mov_b32 v91, 0
    v_mov_b32 v92, 0
    v_mov_b32 v93, 0
    v_mov_b32 v94, 0
    v_mov_b32 v95, 0
    v_mov_b32 v96, 0
    v_mov_b32 v97, 0
    v_mov_b32 v98, 0
    v_mov_b32 v99, 0
    v_mov_b32 v100, 0
    v_mov_b32 v101, 0
    v_mov_b32 v102, 0
    v_mov_b32 v103, 0
    v_mov_b32 v104, 0
    v_mov_b32 v105, 0
    v_mov_b32 v106, 0
    v_mov_b32 v107, 0
    v_mov_b32 v108, 0
    v_mov_b32 v109, 0
    v_mov_b32 v110, 0
    v_mov_b32 v111, 0
    v_mov_b32 v112, 0
    v_mov_b32 v113, 0
    v_mov_b32 v114, 0
    v_mov_b32 v115, 0
    v_mov_b32 v116, 0
    v_mov_b32 v117, 0
    v_mov_b32 v118, 0
    v_mov_b32 v119, 0
    v_mov_b32 v120, 0
    v_mov_b32 v121, 0
    v_mov_b32 v122, 0
    v_mov_b32 v123, 0
    v_mov_b32 v124, 0
    v_mov_b32 v125, 0
    v_mov_b32 v126, 0
    v_mov_b32 v127, 0
    s_add_u32 m0, s30, 0
    s_nop 0
    buffer_load_dwordx4 v11, s[8:11], s20 offen lds
    s_add_u32 s20, s20, 128
    s_add_u32 m0, s30, 1024
    s_nop 0
    buffer_load_dwordx4 v11, s[8:11], s21 offen lds
    s_add_u32 s21, s21, 128
    s_add_u32 m0, s30, 2048
    s_nop 0
    buffer_load_dwordx4 v11, s[8:11], s22 offen lds
    s_add_u32 s22, s22, 128
    s_add_u32 m0, s30, 3072
    s_nop 0
    buffer_load_dwordx4 v11, s[8:11], s23 offen lds
    s_add_u32 s23, s23, 128
    s_add_u32 m0, s31, 0
    s_nop 0
    buffer_load_dwordx4 v12, s[12:15], s24 offen lds
    s_add_u32 s24, s24, 73728
    s_add_u32 m0, s31, 1024
    s_nop 0
    buffer_load_dwordx4 v13, s[12:15], s25 offen lds
    s_add_u32 s25, s25, 73728
    s_add_u32 m0, s31, 2048
    s_nop 0
    buffer_load_dwordx4 v12, s[12:15], s26 offen lds
    s_add_u32 s26, s26, 73728
    s_add_u32 m0, s31, 3072
    s_nop 0
    buffer_load_dwordx4 v13, s[12:15], s27 offen lds
    s_add_u32 s27, s27, 73728
    s_add_u32 m0, s31, 4096
    s_nop 0
    buffer_load_dwordx4 v12, s[12:15], s28 offen lds
    s_add_u32 s28, s28, 73728
    s_add_u32 m0, s31, 5120
    s_nop 0
    buffer_load_dwordx4 v13, s[12:15], s29 offen lds
    s_add_u32 s29, s29, 73728
    s_add_u32 m0, s30, 40960
    s_nop 0
    buffer_load_dwordx4 v11, s[8:11], s20 offen lds
    s_add_u32 s20, s20, 128
    s_add_u32 m0, s30, 41984
    s_nop 0
    buffer_load_dwordx4 v11, s[8:11], s21 offen lds
    s_add_u32 s21, s21, 128
    s_add_u32 m0, s30, 43008
    s_nop 0
    buffer_load_dwordx4 v11, s[8:11], s22 offen lds
    s_add_u32 s22, s22, 128
    s_add_u32 m0, s30, 44032
    s_nop 0
    buffer_load_dwordx4 v11, s[8:11], s23 offen lds
    s_add_u32 s23, s23, 128
    s_add_u32 m0, s31, 40960
    s_nop 0
    buffer_load_dwordx4 v12, s[12:15], s24 offen lds
    s_add_u32 s24, s24, 73728
    s_add_u32 m0, s31, 41984
    s_nop 0
    buffer_load_dwordx4 v13, s[12:15], s25 offen lds
    s_add_u32 s25, s25, 73728
    s_add_u32 m0, s31, 43008
    s_nop 0
    buffer_load_dwordx4 v12, s[12:15], s26 offen lds
    s_add_u32 s26, s26, 73728
    s_add_u32 m0, s31, 44032
    s_nop 0
    buffer_load_dwordx4 v13, s[12:15], s27 offen lds
    s_add_u32 s27, s27, 73728
    s_add_u32 m0, s31, 45056
    s_nop 0
    buffer_load_dwordx4 v12, s[12:15], s28 offen lds
    s_add_u32 s28, s28, 73728
    s_add_u32 m0, s31, 46080
    s_nop 0
    buffer_load_dwordx4 v13, s[12:15], s29 offen lds
    s_add_u32 s29, s29, 73728
    s_add_u32 m0, s30, 81920
    s_nop 0
    buffer_load_dwordx4 v11, s[8:11], s20 offen lds
    s_add_u32 s20, s20, 128
    s_add_u32 m0, s30, 82944
    s_nop 0
    buffer_load_dwordx4 v11, s[8:11], s21 offen lds
    s_add_u32 s21, s21, 128
    s_add_u32 m0, s30, 83968
    s_nop 0
    buffer_load_dwordx4 v11, s[8:11], s22 offen lds
    s_add_u32 s22, s22, 128
    s_add_u32 m0, s30, 84992
    s_nop 0
    buffer_load_dwordx4 v11, s[8:11], s23 offen lds
    s_add_u32 s23, s23, 128
    s_add_u32 m0, s31, 81920
    s_nop 0
    buffer_load_dwordx4 v12, s[12:15], s24 offen lds
    s_add_u32 s24, s24, 73728
    s_add_u32 m0, s31, 82944
    s_nop 0
    buffer_load_dwordx4 v13, s[12:15], s25 offen lds
    s_add_u32 s25, s25, 73728
    s_add_u32 m0, s31, 83968
    s_nop 0
    buffer_load_dwordx4 v12, s[12:15], s26 offen lds
    s_add_u32 s26, s26, 73728
    s_add_u32 m0, s31, 84992
    s_nop 0
    buffer_load_dwordx4 v13, s[12:15], s27 offen lds
    s_add_u32 s27, s27, 73728
    s_add_u32 m0, s31, 86016
    s_nop 0
    buffer_load_dwordx4 v12, s[12:15], s28 offen lds
    s_add_u32 s28, s28, 73728
    s_add_u32 m0, s31, 87040
    s_nop 0
    buffer_load_dwordx4 v13, s[12:15], s29 offen lds
    s_add_u32 s29, s29, 73728
    s_mov_b32 s33, 0
kloop_4:
    s_waitcnt vmcnt(20)
    s_barrier
    ds_read_b128 v[128:131], v14 offset:0
    ds_read_b128 v[132:135], v14 offset:2048
    ds_read_b128 v[136:139], v14 offset:4096
    ds_read_b128 v[140:143], v14 offset:6144
    ds_read_b64_tr_b16 v[144:145], v16 offset:0
    ds_read_b64_tr_b16 v[146:147], v16 offset:512
    ds_read_b64_tr_b16 v[148:149], v17 offset:0
    ds_read_b64_tr_b16 v[150:151], v17 offset:512
    ds_read_b64_tr_b16 v[152:153], v18 offset:0
    ds_read_b64_tr_b16 v[154:155], v18 offset:512
    ds_read_b64_tr_b16 v[156:157], v19 offset:0
    ds_read_b64_tr_b16 v[158:159], v19 offset:512
    ds_read_b64_tr_b16 v[160:161], v20 offset:0
    ds_read_b64_tr_b16 v[162:163], v20 offset:512
    ds_read_b64_tr_b16 v[164:165], v21 offset:0
    ds_read_b64_tr_b16 v[166:167], v21 offset:512
    ds_read_b128 v[168:171], v15 offset:0
    ds_read_b128 v[172:175], v15 offset:2048
    ds_read_b128 v[176:179], v15 offset:4096
    ds_read_b128 v[180:183], v15 offset:6144
    ds_read_b64_tr_b16 v[184:185], v16 offset:4096
    ds_read_b64_tr_b16 v[186:187], v16 offset:4608
    ds_read_b64_tr_b16 v[188:189], v17 offset:4096
    ds_read_b64_tr_b16 v[190:191], v17 offset:4608
    ds_read_b64_tr_b16 v[192:193], v18 offset:4096
    ds_read_b64_tr_b16 v[194:195], v18 offset:4608
    ds_read_b64_tr_b16 v[196:197], v19 offset:4096
    ds_read_b64_tr_b16 v[198:199], v19 offset:4608
    ds_read_b64_tr_b16 v[200:201], v20 offset:4096
    ds_read_b64_tr_b16 v[202:203], v20 offset:4608
    ds_read_b64_tr_b16 v[204:205], v21 offset:4096
    ds_read_b64_tr_b16 v[206:207], v21 offset:4608
    s_add_u32 m0, s30, 122880
    s_nop 0
    buffer_load_dwordx4 v11, s[8:11], s20 offen lds
    s_add_u32 s20, s20, 128
    s_add_u32 m0, s30, 123904
    s_nop 0
    buffer_load_dwordx4 v11, s[8:11], s21 offen lds
    s_add_u32 s21, s21, 128
    s_waitcnt lgkmcnt(15)
    v_mfma_f32_16x16x32_bf16 v[32:35], v[144:147], v[128:131], v[32:35]
    v_mfma_f32_16x16x32_bf16 v[36:39], v[148:151], v[128:131], v[36:39]
    v_mfma_f32_16x16x32_bf16 v[40:43], v[152:155], v[128:131], v[40:43]
    v_mfma_f32_16x16x32_bf16 v[44:47], v[156:159], v[128:131], v[44:47]
    v_mfma_f32_16x16x32_bf16 v[48:51], v[160:163], v[128:131], v[48:51]
    s_add_u32 m0, s30, 124928
    s_nop 0
    buffer_load_dwordx4 v11, s[8:11], s22 offen lds
    s_add_u32 s22, s22, 128
    v_mfma_f32_16x16x32_bf16 v[52:55], v[164:167], v[128:131], v[52:55]
    v_mfma_f32_16x16x32_bf16 v[56:59], v[144:147], v[132:135], v[56:59]
    v_mfma_f32_16x16x32_bf16 v[60:63], v[148:151], v[132:135], v[60:63]
    v_mfma_f32_16x16x32_bf16 v[64:67], v[152:155], v[132:135], v[64:67]
    v_mfma_f32_16x16x32_bf16 v[68:71], v[156:159], v[132:135], v[68:71]
    s_add_u32 m0, s30, 125952
    s_nop 0
    buffer_load_dwordx4 v11, s[8:11], s23 offen lds
    s_add_u32 s23, s23, 128
    v_mfma_f32_16x16x32_bf16 v[72:75], v[160:163], v[132:135], v[72:75]
    v_mfma_f32_16x16x32_bf16 v[76:79], v[164:167], v[132:135], v[76:79]
    v_mfma_f32_16x16x32_bf16 v[80:83], v[144:147], v[136:139], v[80:83]
    v_mfma_f32_16x16x32_bf16 v[84:87], v[148:151], v[136:139], v[84:87]
    v_mfma_f32_16x16x32_bf16 v[88:91], v[152:155], v[136:139], v[88:91]
    s_add_u32 m0, s31, 122880
    s_nop 0
    buffer_load_dwordx4 v12, s[12:15], s24 offen lds
    s_add_u32 s24, s24, 73728
    v_mfma_f32_16x16x32_bf16 v[92:95], v[156:159], v[136:139], v[92:95]
    v_mfma_f32_16x16x32_bf16 v[96:99], v[160:163], v[136:139], v[96:99]
    v_mfma_f32_16x16x32_bf16 v[100:103], v[164:167], v[136:139], v[100:103]
    v_mfma_f32_16x16x32_bf16 v[104:107], v[144:147], v[140:143], v[104:107]
    v_mfma_f32_16x16x32_bf16 v[108:111], v[148:151], v[140:143], v[108:111]
    s_add_u32 m0, s31, 123904
    s_nop 0
    buffer_load_dwordx4 v13, s[12:15], s25 offen lds
    s_add_u32 s25, s25, 73728
    v_mfma_f32_16x16x32_bf16 v[112:115], v[152:155], v[140:143], v[112:115]
    v_mfma_f32_16x16x32_bf16 v[116:119], v[156:159], v[140:143], v[116:119]
    v_mfma_f32_16x16x32_bf16 v[120:123], v[160:163], v[140:143], v[120:123]
    v_mfma_f32_16x16x32_bf16 v[124:127], v[164:167], v[140:143], v[124:127]
    s_waitcnt lgkmcnt(0)
    v_mfma_f32_16x16x32_bf16 v[32:35], v[184:187], v[168:171], v[32:35]
    s_add_u32 m0, s31, 124928
    s_nop 0
    buffer_load_dwordx4 v12, s[12:15], s26 offen lds
    s_add_u32 s26, s26, 73728
    v_mfma_f32_16x16x32_bf16 v[36:39], v[188:191], v[168:171], v[36:39]
    v_mfma_f32_16x16x32_bf16 v[40:43], v[192:195], v[168:171], v[40:43]
    v_mfma_f32_16x16x32_bf16 v[44:47], v[196:199], v[168:171], v[44:47]
    v_mfma_f32_16x16x32_bf16 v[48:51], v[200:203], v[168:171], v[48:51]
    v_mfma_f32_16x16x32_bf16 v[52:55], v[204:207], v[168:171], v[52:55]
    s_add_u32 m0, s31, 125952
    s_nop 0
    buffer_load_dwordx4 v13, s[12:15], s27 offen lds
    s_add_u32 s27, s27, 73728
    v_mfma_f32_16x16x32_bf16 v[56:59], v[184:187], v[172:175], v[56:59]
    v_mfma_f32_16x16x32_bf16 v[60:63], v[188:191], v[172:175], v[60:63]
    v_mfma_f32_16x16x32_bf16 v[64:67], v[192:195], v[172:175], v[64:67]
    v_mfma_f32_16x16x32_bf16 v[68:71], v[196:199], v[172:175], v[68:71]
    v_mfma_f32_16x16x32_bf16 v[72:75], v[200:203], v[172:175], v[72:75]
    s_add_u32 m0, s31, 126976
    s_nop 0
    buffer_load_dwordx4 v12, s[12:15], s28 offen lds
    s_add_u32 s28, s28, 73728
    v_mfma_f32_16x16x32_bf16 v[76:79], v[204:207], v[172:175], v[76:79]
    v_mfma_f32_16x16x32_bf16 v[80:83], v[184:187], v[176:179], v[80:83]
    v_mfma_f32_16x16x32_bf16 v[84:87], v[188:191], v[176:179], v[84:87]
    v_mfma_f32_16x16x32_bf16 v[88:91], v[192:195], v[176:179], v[88:91]
    v_mfma_f32_16x16x32_bf16 v[92:95], v[196:199], v[176:179], v[92:95]
    s_add_u32 m0, s31, 128000
    s_nop 0
    buffer_load_dwordx4 v13, s[12:15], s29 offen lds
    s_add_u32 s29, s29, 73728
    v_mfma_f32_16x16x32_bf16 v[96:99], v[200:203], v[176:179], v[96:99]
    v_mfma_f32_16x16x32_bf16 v[100:103], v[204:207], v[176:179], v[100:103]
    v_mfma_f32_16x16x32_bf16 v[104:107], v[184:187], v[180:183], v[104:107]
    v_mfma_f32_16x16x32_bf16 v[108:111], v[188:191], v[180:183], v[108:111]
    v_mfma_f32_16x16x32_bf16 v[112:115], v[192:195], v[180:183], v[112:115]
    v_mfma_f32_16x16x32_bf16 v[116:119], v[196:199], v[180:183], v[116:119]
    v_mfma_f32_16x16x32_bf16 v[120:123], v[200:203], v[180:183], v[120:123]
    v_mfma_f32_16x16x32_bf16 v[124:127], v[204:207], v[180:183], v[124:127]
    s_waitcnt vmcnt(20)
    s_barrier
    ds_read_b128 v[128:131], v14 offset:40960
    ds_read_b128 v[132:135], v14 offset:43008
    ds_read_b128 v[136:139], v14 offset:45056
    ds_read_b128 v[140:143], v14 offset:47104
    ds_read_b64_tr_b16 v[144:145], v16 offset:40960
    ds_read_b64_tr_b16 v[146:147], v16 offset:41472
    ds_read_b64_tr_b16 v[148:149], v17 offset:40960
    ds_read_b64_tr_b16 v[150:151], v17 offset:41472
    ds_read_b64_tr_b16 v[152:153], v18 offset:40960
    ds_read_b64_tr_b16 v[154:155], v18 offset:41472
    ds_read_b64_tr_b16 v[156:157], v19 offset:40960
    ds_read_b64_tr_b16 v[158:159], v19 offset:41472
    ds_read_b64_tr_b16 v[160:161], v20 offset:40960
    ds_read_b64_tr_b16 v[162:163], v20 offset:41472
    ds_read_b64_tr_b16 v[164:165], v21 offset:40960
    ds_read_b64_tr_b16 v[166:167], v21 offset:41472
    ds_read_b128 v[168:171], v15 offset:40960
    ds_read_b128 v[172:175], v15 offset:43008
    ds_read_b128 v[176:179], v15 offset:45056
    ds_read_b128 v[180:183], v15 offset:47104
    ds_read_b64_tr_b16 v[184:185], v16 offset:45056
    ds_read_b64_tr_b16 v[186:187], v16 offset:45568
    ds_read_b64_tr_b16 v[188:189], v17 offset:45056
    ds_read_b64_tr_b16 v[190:191], v17 offset:45568
    ds_read_b64_tr_b16 v[192:193], v18 offset:45056
    ds_read_b64_tr_b16 v[194:195], v18 offset:45568
    ds_read_b64_tr_b16 v[196:197], v19 offset:45056
    ds_read_b64_tr_b16 v[198:199], v19 offset:45568
    ds_read_b64_tr_b16 v[200:201], v20 offset:45056
    ds_read_b64_tr_b16 v[202:203], v20 offset:45568
    ds_read_b64_tr_b16 v[204:205], v21 offset:45056
    ds_read_b64_tr_b16 v[206:207], v21 offset:45568
    s_add_u32 m0, s30, 0
    s_nop 0
    buffer_load_dwordx4 v11, s[8:11], s20 offen lds
    s_add_u32 s20, s20, 128
    s_add_u32 m0, s30, 1024
    s_nop 0
    buffer_load_dwordx4 v11, s[8:11], s21 offen lds
    s_add_u32 s21, s21, 128
    s_waitcnt lgkmcnt(15)
    v_mfma_f32_16x16x32_bf16 v[32:35], v[144:147], v[128:131], v[32:35]
    v_mfma_f32_16x16x32_bf16 v[36:39], v[148:151], v[128:131], v[36:39]
    v_mfma_f32_16x16x32_bf16 v[40:43], v[152:155], v[128:131], v[40:43]
    v_mfma_f32_16x16x32_bf16 v[44:47], v[156:159], v[128:131], v[44:47]
    v_mfma_f32_16x16x32_bf16 v[48:51], v[160:163], v[128:131], v[48:51]
    s_add_u32 m0, s30, 2048
    s_nop 0
    buffer_load_dwordx4 v11, s[8:11], s22 offen lds
    s_add_u32 s22, s22, 128
    v_mfma_f32_16x16x32_bf16 v[52:55], v[164:167], v[128:131], v[52:55]
    v_mfma_f32_16x16x32_bf16 v[56:59], v[144:147], v[132:135], v[56:59]
    v_mfma_f32_16x16x32_bf16 v[60:63], v[148:151], v[132:135], v[60:63]
    v_mfma_f32_16x16x32_bf16 v[64:67], v[152:155], v[132:135], v[64:67]
    v_mfma_f32_16x16x32_bf16 v[68:71], v[156:159], v[132:135], v[68:71]
    s_add_u32 m0, s30, 3072
    s_nop 0
    buffer_load_dwordx4 v11, s[8:11], s23 offen lds
    s_add_u32 s23, s23, 128
    v_mfma_f32_16x16x32_bf16 v[72:75], v[160:163], v[132:135], v[72:75]
    v_mfma_f32_16x16x32_bf16 v[76:79], v[164:167], v[132:135], v[76:79]
    v_mfma_f32_16x16x32_bf16 v[80:83], v[144:147], v[136:139], v[80:83]
    v_mfma_f32_16x16x32_bf16 v[84:87], v[148:151], v[136:139], v[84:87]
    v_mfma_f32_16x16x32_bf16 v[88:91], v[152:155], v[136:139], v[88:91]
    s_add_u32 m0, s31, 0
    s_nop 0
    buffer_load_dwordx4 v12, s[12:15], s24 offen lds
    s_add_u32 s24, s24, 73728
    v_mfma_f32_16x16x32_bf16 v[92:95], v[156:159], v[136:139], v[92:95]
    v_mfma_f32_16x16x32_bf16 v[96:99], v[160:163], v[136:139], v[96:99]
    v_mfma_f32_16x16x32_bf16 v[100:103], v[164:167], v[136:139], v[100:103]
    v_mfma_f32_16x16x32_bf16 v[104:107], v[144:147], v[140:143], v[104:107]
    v_mfma_f32_16x16x32_bf16 v[108:111], v[148:151], v[140:143], v[108:111]
    s_add_u32 m0, s31, 1024
    s_nop 0
    buffer_load_dwordx4 v13, s[12:15], s25 offen lds
    s_add_u32 s25, s25, 73728
    v_mfma_f32_16x16x32_bf16 v[112:115], v[152:155], v[140:143], v[112:115]
    v_mfma_f32_16x16x32_bf16 v[116:119], v[156:159], v[140:143], v[116:119]
    v_mfma_f32_16x16x32_bf16 v[120:123], v[160:163], v[140:143], v[120:123]
    v_mfma_f32_16x16x32_bf16 v[124:127], v[164:167], v[140:143], v[124:127]
    s_waitcnt lgkmcnt(0)
    v_mfma_f32_16x16x32_bf16 v[32:35], v[184:187], v[168:171], v[32:35]
    s_add_u32 m0, s31, 2048
    s_nop 0
    buffer_load_dwordx4 v12, s[12:15], s26 offen lds
    s_add_u32 s26, s26, 73728
    v_mfma_f32_16x16x32_bf16 v[36:39], v[188:191], v[168:171], v[36:39]
    v_mfma_f32_16x16x32_bf16 v[40:43], v[192:195], v[168:171], v[40:43]
    v_mfma_f32_16x16x32_bf16 v[44:47], v[196:199], v[168:171], v[44:47]
    v_mfma_f32_16x16x32_bf16 v[48:51], v[200:203], v[168:171], v[48:51]
    v_mfma_f32_16x16x32_bf16 v[52:55], v[204:207], v[168:171], v[52:55]
    s_add_u32 m0, s31, 3072
    s_nop 0
    buffer_load_dwordx4 v13, s[12:15], s27 offen lds
    s_add_u32 s27, s27, 73728
    v_mfma_f32_16x16x32_bf16 v[56:59], v[184:187], v[172:175], v[56:59]
    v_mfma_f32_16x16x32_bf16 v[60:63], v[188:191], v[172:175], v[60:63]
    v_mfma_f32_16x16x32_bf16 v[64:67], v[192:195], v[172:175], v[64:67]
    v_mfma_f32_16x16x32_bf16 v[68:71], v[196:199], v[172:175], v[68:71]
    v_mfma_f32_16x16x32_bf16 v[72:75], v[200:203], v[172:175], v[72:75]
    s_add_u32 m0, s31, 4096
    s_nop 0
    buffer_load_dwordx4 v12, s[12:15], s28 offen lds
    s_add_u32 s28, s28, 73728
    v_mfma_f32_16x16x32_bf16 v[76:79], v[204:207], v[172:175], v[76:79]
    v_mfma_f32_16x16x32_bf16 v[80:83], v[184:187], v[176:179], v[80:83]
    v_mfma_f32_16x16x32_bf16 v[84:87], v[188:191], v[176:179], v[84:87]
    v_mfma_f32_16x16x32_bf16 v[88:91], v[192:195], v[176:179], v[88:91]
    v_mfma_f32_16x16x32_bf16 v[92:95], v[196:199], v[176:179], v[92:95]
    s_add_u32 m0, s31, 5120
    s_nop 0
    buffer_load_dwordx4 v13, s[12:15], s29 offen lds
    s_add_u32 s29, s29, 73728
    v_mfma_f32_16x16x32_bf16 v[96:99], v[200:203], v[176:179], v[96:99]
    v_mfma_f32_16x16x32_bf16 v[100:103], v[204:207], v[176:179], v[100:103]
    v_mfma_f32_16x16x32_bf16 v[104:107], v[184:187], v[180:183], v[104:107]
    v_mfma_f32_16x16x32_bf16 v[108:111], v[188:191], v[180:183], v[108:111]
    v_mfma_f32_16x16x32_bf16 v[112:115], v[192:195], v[180:183], v[112:115]
    v_mfma_f32_16x16x32_bf16 v[116:119], v[196:199], v[180:183], v[116:119]
    v_mfma_f32_16x16x32_bf16 v[120:123], v[200:203], v[180:183], v[120:123]
    v_mfma_f32_16x16x32_bf16 v[124:127], v[204:207], v[180:183], v[124:127]
    s_waitcnt vmcnt(20)
    s_barrier
    ds_read_b128 v[128:131], v22 offset:0
    ds_read_b128 v[132:135], v22 offset:2048
    ds_read_b128 v[136:139], v22 offset:4096
    ds_read_b128 v[140:143], v22 offset:6144
    ds_read_b64_tr_b16 v[144:145], v24 offset:0
    ds_read_b64_tr_b16 v[146:147], v24 offset:512
    ds_read_b64_tr_b16 v[148:149], v25 offset:0
    ds_read_b64_tr_b16 v[150:151], v25 offset:512
    ds_read_b64_tr_b16 v[152:153], v26 offset:0
    ds_read_b64_tr_b16 v[154:155], v26 offset:512
    ds_read_b64_tr_b16 v[156:157], v27 offset:0
    ds_read_b64_tr_b16 v[158:159], v27 offset:512
    ds_read_b64_tr_b16 v[160:161], v28 offset:0
    ds_read_b64_tr_b16 v[162:163], v28 offset:512
    ds_read_b64_tr_b16 v[164:165], v29 offset:0
    ds_read_b64_tr_b16 v[166:167], v29 offset:512
    ds_read_b128 v[168:171], v23 offset:0
    ds_read_b128 v[172:175], v23 offset:2048
    ds_read_b128 v[176:179], v23 offset:4096
    ds_read_b128 v[180:183], v23 offset:6144
    ds_read_b64_tr_b16 v[184:185], v24 offset:4096
    ds_read_b64_tr_b16 v[186:187], v24 offset:4608
    ds_read_b64_tr_b16 v[188:189], v25 offset:4096
    ds_read_b64_tr_b16 v[190:191], v25 offset:4608
    ds_read_b64_tr_b16 v[192:193], v26 offset:4096
    ds_read_b64_tr_b16 v[194:195], v26 offset:4608
    ds_read_b64_tr_b16 v[196:197], v27 offset:4096
    ds_read_b64_tr_b16 v[198:199], v27 offset:4608
    ds_read_b64_tr_b16 v[200:201], v28 offset:4096
    ds_read_b64_tr_b16 v[202:203], v28 offset:4608
    ds_read_b64_tr_b16 v[204:205], v29 offset:4096
    ds_read_b64_tr_b16 v[206:207], v29 offset:4608
    s_add_u32 m0, s30, 40960
    s_nop 0
    buffer_load_dwordx4 v11, s[8:11], s20 offen lds
    s_add_u32 s20, s20, 128
    s_add_u32 m0, s30, 41984
    s_nop 0
    buffer_load_dwordx4 v11, s[8:11], s21 offen lds
    s_add_u32 s21, s21, 128
    s_waitcnt lgkmcnt(15)
    v_mfma_f32_16x16x32_bf16 v[32:35], v[144:147], v[128:131], v[32:35]
    v_mfma_f32_16x16x32_bf16 v[36:39], v[148:151], v[128:131], v[36:39]
    v_mfma_f32_16x16x32_bf16 v[40:43], v[152:155], v[128:131], v[40:43]
    v_mfma_f32_16x16x32_bf16 v[44:47], v[156:159], v[128:131], v[44:47]
    v_mfma_f32_16x16x32_bf16 v[48:51], v[160:163], v[128:131], v[48:51]
    s_add_u32 m0, s30, 43008
    s_nop 0
    buffer_load_dwordx4 v11, s[8:11], s22 offen lds
    s_add_u32 s22, s22, 128
    v_mfma_f32_16x16x32_bf16 v[52:55], v[164:167], v[128:131], v[52:55]
    v_mfma_f32_16x16x32_bf16 v[56:59], v[144:147], v[132:135], v[56:59]
    v_mfma_f32_16x16x32_bf16 v[60:63], v[148:151], v[132:135], v[60:63]
    v_mfma_f32_16x16x32_bf16 v[64:67], v[152:155], v[132:135], v[64:67]
    v_mfma_f32_16x16x32_bf16 v[68:71], v[156:159], v[132:135], v[68:71]
    s_add_u32 m0, s30, 44032
    s_nop 0
    buffer_load_dwordx4 v11, s[8:11], s23 offen lds
    s_add_u32 s23, s23, 128
    v_mfma_f32_16x16x32_bf16 v[72:75], v[160:163], v[132:135], v[72:75]
    v_mfma_f32_16x16x32_bf16 v[76:79], v[164:167], v[132:135], v[76:79]
    v_mfma_f32_16x16x32_bf16 v[80:83], v[144:147], v[136:139], v[80:83]
    v_mfma_f32_16x16x32_bf16 v[84:87], v[148:151], v[136:139], v[84:87]
    v_mfma_f32_16x16x32_bf16 v[88:91], v[152:155], v[136:139], v[88:91]
    s_add_u32 m0, s31, 40960
    s_nop 0
    buffer_load_dwordx4 v12, s[12:15], s24 offen lds
    s_add_u32 s24, s24, 73728
    v_mfma_f32_16x16x32_bf16 v[92:95], v[156:159], v[136:139], v[92:95]
    v_mfma_f32_16x16x32_bf16 v[96:99], v[160:163], v[136:139], v[96:99]
    v_mfma_f32_16x16x32_bf16 v[100:103], v[164:167], v[136:139], v[100:103]
    v_mfma_f32_16x16x32_bf16 v[104:107], v[144:147], v[140:143], v[104:107]
    v_mfma_f32_16x16x32_bf16 v[108:111], v[148:151], v[140:143], v[108:111]
    s_add_u32 m0, s31, 41984
    s_nop 0
    buffer_load_dwordx4 v13, s[12:15], s25 offen lds
    s_add_u32 s25, s25, 73728
    v_mfma_f32_16x16x32_bf16 v[112:115], v[152:155], v[140:143], v[112:115]
    v_mfma_f32_16x16x32_bf16 v[116:119], v[156:159], v[140:143], v[116:119]
    v_mfma_f32_16x16x32_bf16 v[120:123], v[160:163], v[140:143], v[120:123]
    v_mfma_f32_16x16x32_bf16 v[124:127], v[164:167], v[140:143], v[124:127]
    s_waitcnt lgkmcnt(0)
    v_mfma_f32_16x16x32_bf16 v[32:35], v[184:187], v[168:171], v[32:35]
    s_add_u32 m0, s31, 43008
    s_nop 0
    buffer_load_dwordx4 v12, s[12:15], s26 offen lds
    s_add_u32 s26, s26, 73728
    v_mfma_f32_16x16x32_bf16 v[36:39], v[188:191], v[168:171], v[36:39]
    v_mfma_f32_16x16x32_bf16 v[40:43], v[192:195], v[168:171], v[40:43]
    v_mfma_f32_16x16x32_bf16 v[44:47], v[196:199], v[168:171], v[44:47]
    v_mfma_f32_16x16x32_bf16 v[48:51], v[200:203], v[168:171], v[48:51]
    v_mfma_f32_16x16x32_bf16 v[52:55], v[204:207], v[168:171], v[52:55]
    s_add_u32 m0, s31, 44032
    s_nop 0
    buffer_load_dwordx4 v13, s[12:15], s27 offen lds
    s_add_u32 s27, s27, 73728
    v_mfma_f32_16x16x32_bf16 v[56:59], v[184:187], v[172:175], v[56:59]
    v_mfma_f32_16x16x32_bf16 v[60:63], v[188:191], v[172:175], v[60:63]
    v_mfma_f32_16x16x32_bf16 v[64:67], v[192:195], v[172:175], v[64:67]
    v_mfma_f32_16x16x32_bf16 v[68:71], v[196:199], v[172:175], v[68:71]
    v_mfma_f32_16x16x32_bf16 v[72:75], v[200:203], v[172:175], v[72:75]
    s_add_u32 m0, s31, 45056
    s_nop 0
    buffer_load_dwordx4 v12, s[12:15], s28 offen lds
    s_add_u32 s28, s28, 73728
    v_mfma_f32_16x16x32_bf16 v[76:79], v[204:207], v[172:175], v[76:79]
    v_mfma_f32_16x16x32_bf16 v[80:83], v[184:187], v[176:179], v[80:83]
    v_mfma_f32_16x16x32_bf16 v[84:87], v[188:191], v[176:179], v[84:87]
    v_mfma_f32_16x16x32_bf16 v[88:91], v[192:195], v[176:179], v[88:91]
    v_mfma_f32_16x16x32_bf16 v[92:95], v[196:199], v[176:179], v[92:95]
    s_add_u32 m0, s31, 46080
    s_nop 0
    buffer_load_dwordx4 v13, s[12:15], s29 offen lds
    s_add_u32 s29, s29, 73728
    v_mfma_f32_16x16x32_bf16 v[96:99], v[200:203], v[176:179], v[96:99]
    v_mfma_f32_16x16x32_bf16 v[100:103], v[204:207], v[176:179], v[100:103]
    v_mfma_f32_16x16x32_bf16 v[104:107], v[184:187], v[180:183], v[104:107]
    v_mfma_f32_16x16x32_bf16 v[108:111], v[188:191], v[180:183], v[108:111]
    v_mfma_f32_16x16x32_bf16 v[112:115], v[192:195], v[180:183], v[112:115]
    v_mfma_f32_16x16x32_bf16 v[116:119], v[196:199], v[180:183], v[116:119]
    v_mfma_f32_16x16x32_bf16 v[120:123], v[200:203], v[180:183], v[120:123]
    v_mfma_f32_16x16x32_bf16 v[124:127], v[204:207], v[180:183], v[124:127]
    s_waitcnt vmcnt(20)
    s_barrier
    ds_read_b128 v[128:131], v22 offset:40960
    ds_read_b128 v[132:135], v22 offset:43008
    ds_read_b128 v[136:139], v22 offset:45056
    ds_read_b128 v[140:143], v22 offset:47104
    ds_read_b64_tr_b16 v[144:145], v24 offset:40960
    ds_read_b64_tr_b16 v[146:147], v24 offset:41472
    ds_read_b64_tr_b16 v[148:149], v25 offset:40960
    ds_read_b64_tr_b16 v[150:151], v25 offset:41472
    ds_read_b64_tr_b16 v[152:153], v26 offset:40960
    ds_read_b64_tr_b16 v[154:155], v26 offset:41472
    ds_read_b64_tr_b16 v[156:157], v27 offset:40960
    ds_read_b64_tr_b16 v[158:159], v27 offset:41472
    ds_read_b64_tr_b16 v[160:161], v28 offset:40960
    ds_read_b64_tr_b16 v[162:163], v28 offset:41472
    ds_read_b64_tr_b16 v[164:165], v29 offset:40960
    ds_read_b64_tr_b16 v[166:167], v29 offset:41472
    ds_read_b128 v[168:171], v23 offset:40960
    ds_read_b128 v[172:175], v23 offset:43008
    ds_read_b128 v[176:179], v23 offset:45056
    ds_read_b128 v[180:183], v23 offset:47104
    ds_read_b64_tr_b16 v[184:185], v24 offset:45056
    ds_read_b64_tr_b16 v[186:187], v24 offset:45568
    ds_read_b64_tr_b16 v[188:189], v25 offset:45056
    ds_read_b64_tr_b16 v[190:191], v25 offset:45568
    ds_read_b64_tr_b16 v[192:193], v26 offset:45056
    ds_read_b64_tr_b16 v[194:195], v26 offset:45568
    ds_read_b64_tr_b16 v[196:197], v27 offset:45056
    ds_read_b64_tr_b16 v[198:199], v27 offset:45568
    ds_read_b64_tr_b16 v[200:201], v28 offset:45056
    ds_read_b64_tr_b16 v[202:203], v28 offset:45568
    ds_read_b64_tr_b16 v[204:205], v29 offset:45056
    ds_read_b64_tr_b16 v[206:207], v29 offset:45568
    s_add_u32 m0, s30, 81920
    s_nop 0
    buffer_load_dwordx4 v11, s[8:11], s20 offen lds
    s_add_u32 s20, s20, 128
    s_add_u32 m0, s30, 82944
    s_nop 0
    buffer_load_dwordx4 v11, s[8:11], s21 offen lds
    s_add_u32 s21, s21, 128
    s_waitcnt lgkmcnt(15)
    v_mfma_f32_16x16x32_bf16 v[32:35], v[144:147], v[128:131], v[32:35]
    v_mfma_f32_16x16x32_bf16 v[36:39], v[148:151], v[128:131], v[36:39]
    v_mfma_f32_16x16x32_bf16 v[40:43], v[152:155], v[128:131], v[40:43]
    v_mfma_f32_16x16x32_bf16 v[44:47], v[156:159], v[128:131], v[44:47]
    v_mfma_f32_16x16x32_bf16 v[48:51], v[160:163], v[128:131], v[48:51]
    s_add_u32 m0, s30, 83968
    s_nop 0
    buffer_load_dwordx4 v11, s[8:11], s22 offen lds
    s_add_u32 s22, s22, 128
    v_mfma_f32_16x16x32_bf16 v[52:55], v[164:167], v[128:131], v[52:55]
    v_mfma_f32_16x16x32_bf16 v[56:59], v[144:147], v[132:135], v[56:59]
    v_mfma_f32_16x16x32_bf16 v[60:63], v[148:151], v[132:135], v[60:63]
    v_mfma_f32_16x16x32_bf16 v[64:67], v[152:155], v[132:135], v[64:67]
    v_mfma_f32_16x16x32_bf16 v[68:71], v[156:159], v[132:135], v[68:71]
    s_add_u32 m0, s30, 84992
    s_nop 0
    buffer_load_dwordx4 v11, s[8:11], s23 offen lds
    s_add_u32 s23, s23, 128
    v_mfma_f32_16x16x32_bf16 v[72:75], v[160:163], v[132:135], v[72:75]
    v_mfma_f32_16x16x32_bf16 v[76:79], v[164:167], v[132:135], v[76:79]
    v_mfma_f32_16x16x32_bf16 v[80:83], v[144:147], v[136:139], v[80:83]
    v_mfma_f32_16x16x32_bf16 v[84:87], v[148:151], v[136:139], v[84:87]
    v_mfma_f32_16x16x32_bf16 v[88:91], v[152:155], v[136:139], v[88:91]
    s_add_u32 m0, s31, 81920
    s_nop 0
    buffer_load_dwordx4 v12, s[12:15], s24 offen lds
    s_add_u32 s24, s24, 73728
    v_mfma_f32_16x16x32_bf16 v[92:95], v[156:159], v[136:139], v[92:95]
    v_mfma_f32_16x16x32_bf16 v[96:99], v[160:163], v[136:139], v[96:99]
    v_mfma_f32_16x16x32_bf16 v[100:103], v[164:167], v[136:139], v[100:103]
    v_mfma_f32_16x16x32_bf16 v[104:107], v[144:147], v[140:143], v[104:107]
    v_mfma_f32_16x16x32_bf16 v[108:111], v[148:151], v[140:143], v[108:111]
    s_add_u32 m0, s31, 82944
    s_nop 0
    buffer_load_dwordx4 v13, s[12:15], s25 offen lds
    s_add_u32 s25, s25, 73728
    v_mfma_f32_16x16x32_bf16 v[112:115], v[152:155], v[140:143], v[112:115]
    v_mfma_f32_16x16x32_bf16 v[116:119], v[156:159], v[140:143], v[116:119]
    v_mfma_f32_16x16x32_bf16 v[120:123], v[160:163], v[140:143], v[120:123]
    v_mfma_f32_16x16x32_bf16 v[124:127], v[164:167], v[140:143], v[124:127]
    s_waitcnt lgkmcnt(0)
    v_mfma_f32_16x16x32_bf16 v[32:35], v[184:187], v[168:171], v[32:35]
    s_add_u32 m0, s31, 83968
    s_nop 0
    buffer_load_dwordx4 v12, s[12:15], s26 offen lds
    s_add_u32 s26, s26, 73728
    v_mfma_f32_16x16x32_bf16 v[36:39], v[188:191], v[168:171], v[36:39]
    v_mfma_f32_16x16x32_bf16 v[40:43], v[192:195], v[168:171], v[40:43]
    v_mfma_f32_16x16x32_bf16 v[44:47], v[196:199], v[168:171], v[44:47]
    v_mfma_f32_16x16x32_bf16 v[48:51], v[200:203], v[168:171], v[48:51]
    v_mfma_f32_16x16x32_bf16 v[52:55], v[204:207], v[168:171], v[52:55]
    s_add_u32 m0, s31, 84992
    s_nop 0
    buffer_load_dwordx4 v13, s[12:15], s27 offen lds
    s_add_u32 s27, s27, 73728
    v_mfma_f32_16x16x32_bf16 v[56:59], v[184:187], v[172:175], v[56:59]
    v_mfma_f32_16x16x32_bf16 v[60:63], v[188:191], v[172:175], v[60:63]
    v_mfma_f32_16x16x32_bf16 v[64:67], v[192:195], v[172:175], v[64:67]
    v_mfma_f32_16x16x32_bf16 v[68:71], v[196:199], v[172:175], v[68:71]
    v_mfma_f32_16x16x32_bf16 v[72:75], v[200:203], v[172:175], v[72:75]
    s_add_u32 m0, s31, 86016
    s_nop 0
    buffer_load_dwordx4 v12, s[12:15], s28 offen lds
    s_add_u32 s28, s28, 73728
    v_mfma_f32_16x16x32_bf16 v[76:79], v[204:207], v[172:175], v[76:79]
    v_mfma_f32_16x16x32_bf16 v[80:83], v[184:187], v[176:179], v[80:83]
    v_mfma_f32_16x16x32_bf16 v[84:87], v[188:191], v[176:179], v[84:87]
    v_mfma_f32_16x16x32_bf16 v[88:91], v[192:195], v[176:179], v[88:91]
    v_mfma_f32_16x16x32_bf16 v[92:95], v[196:199], v[176:179], v[92:95]
    s_add_u32 m0, s31, 87040
    s_nop 0
    buffer_load_dwordx4 v13, s[12:15], s29 offen lds
    s_add_u32 s29, s29, 73728
    v_mfma_f32_16x16x32_bf16 v[96:99], v[200:203], v[176:179], v[96:99]
    v_mfma_f32_16x16x32_bf16 v[100:103], v[204:207], v[176:179], v[100:103]
    v_mfma_f32_16x16x32_bf16 v[104:107], v[184:187], v[180:183], v[104:107]
    v_mfma_f32_16x16x32_bf16 v[108:111], v[188:191], v[180:183], v[108:111]
    v_mfma_f32_16x16x32_bf16 v[112:115], v[192:195], v[180:183], v[112:115]
    v_mfma_f32_16x16x32_bf16 v[116:119], v[196:199], v[180:183], v[116:119]
    v_mfma_f32_16x16x32_bf16 v[120:123], v[200:203], v[180:183], v[120:123]
    v_mfma_f32_16x16x32_bf16 v[124:127], v[204:207], v[180:183], v[124:127]
    s_add_u32 s33, s33, 1
    s_cmp_lt_u32 s33, 5
    s_cbranch_scc1 kloop_4
    s_waitcnt vmcnt(20)
    s_barrier
    ds_read_b128 v[128:131], v14 offset:0
    ds_read_b128 v[132:135], v14 offset:2048
    ds_read_b128 v[136:139], v14 offset:4096
    ds_read_b128 v[140:143], v14 offset:6144
    ds_read_b64_tr_b16 v[144:145], v16 offset:0
    ds_read_b64_tr_b16 v[146:147], v16 offset:512
    ds_read_b64_tr_b16 v[148:149], v17 offset:0
    ds_read_b64_tr_b16 v[150:151], v17 offset:512
    ds_read_b64_tr_b16 v[152:153], v18 offset:0
    ds_read_b64_tr_b16 v[154:155], v18 offset:512
    ds_read_b64_tr_b16 v[156:157], v19 offset:0
    ds_read_b64_tr_b16 v[158:159], v19 offset:512
    ds_read_b64_tr_b16 v[160:161], v20 offset:0
    ds_read_b64_tr_b16 v[162:163], v20 offset:512
    ds_read_b64_tr_b16 v[164:165], v21 offset:0
    ds_read_b64_tr_b16 v[166:167], v21 offset:512
    ds_read_b128 v[168:171], v15 offset:0
    ds_read_b128 v[172:175], v15 offset:2048
    ds_read_b128 v[176:179], v15 offset:4096
    ds_read_b128 v[180:183], v15 offset:6144
    ds_read_b64_tr_b16 v[184:185], v16 offset:4096
    ds_read_b64_tr_b16 v[186:187], v16 offset:4608
    ds_read_b64_tr_b16 v[188:189], v17 offset:4096
    ds_read_b64_tr_b16 v[190:191], v17 offset:4608
    ds_read_b64_tr_b16 v[192:193], v18 offset:4096
    ds_read_b64_tr_b16 v[194:195], v18 offset:4608
    ds_read_b64_tr_b16 v[196:197], v19 offset:4096
    ds_read_b64_tr_b16 v[198:199], v19 offset:4608
    ds_read_b64_tr_b16 v[200:201], v20 offset:4096
    ds_read_b64_tr_b16 v[202:203], v20 offset:4608
    ds_read_b64_tr_b16 v[204:205], v21 offset:4096
    ds_read_b64_tr_b16 v[206:207], v21 offset:4608
    s_add_u32 m0, s30, 122880
    s_nop 0
    buffer_load_dwordx4 v11, s[8:11], s20 offen lds
    s_add_u32 s20, s20, 128
    s_add_u32 m0, s30, 123904
    s_nop 0
    buffer_load_dwordx4 v11, s[8:11], s21 offen lds
    s_add_u32 s21, s21, 128
    s_waitcnt lgkmcnt(15)
    v_mfma_f32_16x16x32_bf16 v[32:35], v[144:147], v[128:131], v[32:35]
    v_mfma_f32_16x16x32_bf16 v[36:39], v[148:151], v[128:131], v[36:39]
    v_mfma_f32_16x16x32_bf16 v[40:43], v[152:155], v[128:131], v[40:43]
    v_mfma_f32_16x16x32_bf16 v[44:47], v[156:159], v[128:131], v[44:47]
    v_mfma_f32_16x16x32_bf16 v[48:51], v[160:163], v[128:131], v[48:51]
    s_add_u32 m0, s30, 124928
    s_nop 0
    buffer_load_dwordx4 v11, s[8:11], s22 offen lds
    s_add_u32 s22, s22, 128
    v_mfma_f32_16x16x32_bf16 v[52:55], v[164:167], v[128:131], v[52:55]
    v_mfma_f32_16x16x32_bf16 v[56:59], v[144:147], v[132:135], v[56:59]
    v_mfma_f32_16x16x32_bf16 v[60:63], v[148:151], v[132:135], v[60:63]
    v_mfma_f32_16x16x32_bf16 v[64:67], v[152:155], v[132:135], v[64:67]
    v_mfma_f32_16x16x32_bf16 v[68:71], v[156:159], v[132:135], v[68:71]
    s_add_u32 m0, s30, 125952
    s_nop 0
    buffer_load_dwordx4 v11, s[8:11], s23 offen lds
    s_add_u32 s23, s23, 128
    v_mfma_f32_16x16x32_bf16 v[72:75], v[160:163], v[132:135], v[72:75]
    v_mfma_f32_16x16x32_bf16 v[76:79], v[164:167], v[132:135], v[76:79]
    v_mfma_f32_16x16x32_bf16 v[80:83], v[144:147], v[136:139], v[80:83]
    v_mfma_f32_16x16x32_bf16 v[84:87], v[148:151], v[136:139], v[84:87]
    v_mfma_f32_16x16x32_bf16 v[88:91], v[152:155], v[136:139], v[88:91]
    s_add_u32 m0, s31, 122880
    s_nop 0
    buffer_load_dwordx4 v12, s[12:15], s24 offen lds
    s_add_u32 s24, s24, 73728
    v_mfma_f32_16x16x32_bf16 v[92:95], v[156:159], v[136:139], v[92:95]
    v_mfma_f32_16x16x32_bf16 v[96:99], v[160:163], v[136:139], v[96:99]
    v_mfma_f32_16x16x32_bf16 v[100:103], v[164:167], v[136:139], v[100:103]
    v_mfma_f32_16x16x32_bf16 v[104:107], v[144:147], v[140:143], v[104:107]
    v_mfma_f32_16x16x32_bf16 v[108:111], v[148:151], v[140:143], v[108:111]
    s_add_u32 m0, s31, 123904
    s_nop 0
    buffer_load_dwordx4 v13, s[12:15], s25 offen lds
    s_add_u32 s25, s25, 73728
    v_mfma_f32_16x16x32_bf16 v[112:115], v[152:155], v[140:143], v[112:115]
    v_mfma_f32_16x16x32_bf16 v[116:119], v[156:159], v[140:143], v[116:119]
    v_mfma_f32_16x16x32_bf16 v[120:123], v[160:163], v[140:143], v[120:123]
    v_mfma_f32_16x16x32_bf16 v[124:127], v[164:167], v[140:143], v[124:127]
    s_waitcnt lgkmcnt(0)
    v_mfma_f32_16x16x32_bf16 v[32:35], v[184:187], v[168:171], v[32:35]
    s_add_u32 m0, s31, 124928
    s_nop 0
    buffer_load_dwordx4 v12, s[12:15], s26 offen lds
    s_add_u32 s26, s26, 73728
    v_mfma_f32_16x16x32_bf16 v[36:39], v[188:191], v[168:171], v[36:39]
    v_mfma_f32_16x16x32_bf16 v[40:43], v[192:195], v[168:171], v[40:43]
    v_mfma_f32_16x16x32_bf16 v[44:47], v[196:199], v[168:171], v[44:47]
    v_mfma_f32_16x16x32_bf16 v[48:51], v[200:203], v[168:171], v[48:51]
    v_mfma_f32_16x16x32_bf16 v[52:55], v[204:207], v[168:171], v[52:55]
    s_add_u32 m0, s31, 125952
    s_nop 0
    buffer_load_dwordx4 v13, s[12:15], s27 offen lds
    s_add_u32 s27, s27, 73728
    v_mfma_f32_16x16x32_bf16 v[56:59], v[184:187], v[172:175], v[56:59]
    v_mfma_f32_16x16x32_bf16 v[60:63], v[188:191], v[172:175], v[60:63]
    v_mfma_f32_16x16x32_bf16 v[64:67], v[192:195], v[172:175], v[64:67]
    v_mfma_f32_16x16x32_bf16 v[68:71], v[196:199], v[172:175], v[68:71]
    v_mfma_f32_16x16x32_bf16 v[72:75], v[200:203], v[172:175], v[72:75]
    s_add_u32 m0, s31, 126976
    s_nop 0
    buffer_load_dwordx4 v12, s[12:15], s28 offen lds
    s_add_u32 s28, s28, 73728
    v_mfma_f32_16x16x32_bf16 v[76:79], v[204:207], v[172:175], v[76:79]
    v_mfma_f32_16x16x32_bf16 v[80:83], v[184:187], v[176:179], v[80:83]
    v_mfma_f32_16x16x32_bf16 v[84:87], v[188:191], v[176:179], v[84:87]
    v_mfma_f32_16x16x32_bf16 v[88:91], v[192:195], v[176:179], v[88:91]
    v_mfma_f32_16x16x32_bf16 v[92:95], v[196:199], v[176:179], v[92:95]
    s_add_u32 m0, s31, 128000
    s_nop 0
    buffer_load_dwordx4 v13, s[12:15], s29 offen lds
    s_add_u32 s29, s29, 73728
    v_mfma_f32_16x16x32_bf16 v[96:99], v[200:203], v[176:179], v[96:99]
    v_mfma_f32_16x16x32_bf16 v[100:103], v[204:207], v[176:179], v[100:103]
    v_mfma_f32_16x16x32_bf16 v[104:107], v[184:187], v[180:183], v[104:107]
    v_mfma_f32_16x16x32_bf16 v[108:111], v[188:191], v[180:183], v[108:111]
    v_mfma_f32_16x16x32_bf16 v[112:115], v[192:195], v[180:183], v[112:115]
    v_mfma_f32_16x16x32_bf16 v[116:119], v[196:199], v[180:183], v[116:119]
    v_mfma_f32_16x16x32_bf16 v[120:123], v[200:203], v[180:183], v[120:123]
    v_mfma_f32_16x16x32_bf16 v[124:127], v[204:207], v[180:183], v[124:127]
    s_waitcnt vmcnt(20)
    s_barrier
    ds_read_b128 v[128:131], v14 offset:40960
    ds_read_b128 v[132:135], v14 offset:43008
    ds_read_b128 v[136:139], v14 offset:45056
    ds_read_b128 v[140:143], v14 offset:47104
    ds_read_b64_tr_b16 v[144:145], v16 offset:40960
    ds_read_b64_tr_b16 v[146:147], v16 offset:41472
    ds_read_b64_tr_b16 v[148:149], v17 offset:40960
    ds_read_b64_tr_b16 v[150:151], v17 offset:41472
    ds_read_b64_tr_b16 v[152:153], v18 offset:40960
    ds_read_b64_tr_b16 v[154:155], v18 offset:41472
    ds_read_b64_tr_b16 v[156:157], v19 offset:40960
    ds_read_b64_tr_b16 v[158:159], v19 offset:41472
    ds_read_b64_tr_b16 v[160:161], v20 offset:40960
    ds_read_b64_tr_b16 v[162:163], v20 offset:41472
    ds_read_b64_tr_b16 v[164:165], v21 offset:40960
    ds_read_b64_tr_b16 v[166:167], v21 offset:41472
    ds_read_b128 v[168:171], v15 offset:40960
    ds_read_b128 v[172:175], v15 offset:43008
    ds_read_b128 v[176:179], v15 offset:45056
    ds_read_b128 v[180:183], v15 offset:47104
    ds_read_b64_tr_b16 v[184:185], v16 offset:45056
    ds_read_b64_tr_b16 v[186:187], v16 offset:45568
    ds_read_b64_tr_b16 v[188:189], v17 offset:45056
    ds_read_b64_tr_b16 v[190:191], v17 offset:45568
    ds_read_b64_tr_b16 v[192:193], v18 offset:45056
    ds_read_b64_tr_b16 v[194:195], v18 offset:45568
    ds_read_b64_tr_b16 v[196:197], v19 offset:45056
    ds_read_b64_tr_b16 v[198:199], v19 offset:45568
    ds_read_b64_tr_b16 v[200:201], v20 offset:45056
    ds_read_b64_tr_b16 v[202:203], v20 offset:45568
    ds_read_b64_tr_b16 v[204:205], v21 offset:45056
    ds_read_b64_tr_b16 v[206:207], v21 offset:45568
    s_waitcnt lgkmcnt(15)
    v_mfma_f32_16x16x32_bf16 v[32:35], v[144:147], v[128:131], v[32:35]
    v_mfma_f32_16x16x32_bf16 v[36:39], v[148:151], v[128:131], v[36:39]
    v_mfma_f32_16x16x32_bf16 v[40:43], v[152:155], v[128:131], v[40:43]
    v_mfma_f32_16x16x32_bf16 v[44:47], v[156:159], v[128:131], v[44:47]
    v_mfma_f32_16x16x32_bf16 v[48:51], v[160:163], v[128:131], v[48:51]
    v_mfma_f32_16x16x32_bf16 v[52:55], v[164:167], v[128:131], v[52:55]
    v_mfma_f32_16x16x32_bf16 v[56:59], v[144:147], v[132:135], v[56:59]
    v_mfma_f32_16x16x32_bf16 v[60:63], v[148:151], v[132:135], v[60:63]
    v_mfma_f32_16x16x32_bf16 v[64:67], v[152:155], v[132:135], v[64:67]
    v_mfma_f32_16x16x32_bf16 v[68:71], v[156:159], v[132:135], v[68:71]
    v_mfma_f32_16x16x32_bf16 v[72:75], v[160:163], v[132:135], v[72:75]
    v_mfma_f32_16x16x32_bf16 v[76:79], v[164:167], v[132:135], v[76:79]
    v_mfma_f32_16x16x32_bf16 v[80:83], v[144:147], v[136:139], v[80:83]
    v_mfma_f32_16x16x32_bf16 v[84:87], v[148:151], v[136:139], v[84:87]
    v_mfma_f32_16x16x32_bf16 v[88:91], v[152:155], v[136:139], v[88:91]
    v_mfma_f32_16x16x32_bf16 v[92:95], v[156:159], v[136:139], v[92:95]
    v_mfma_f32_16x16x32_bf16 v[96:99], v[160:163], v[136:139], v[96:99]
    v_mfma_f32_16x16x32_bf16 v[100:103], v[164:167], v[136:139], v[100:103]
    v_mfma_f32_16x16x32_bf16 v[104:107], v[144:147], v[140:143], v[104:107]
    v_mfma_f32_16x16x32_bf16 v[108:111], v[148:151], v[140:143], v[108:111]
    v_mfma_f32_16x16x32_bf16 v[112:115], v[152:155], v[140:143], v[112:115]
    v_mfma_f32_16x16x32_bf16 v[116:119], v[156:159], v[140:143], v[116:119]
    v_mfma_f32_16x16x32_bf16 v[120:123], v[160:163], v[140:143], v[120:123]
    v_mfma_f32_16x16x32_bf16 v[124:127], v[164:167], v[140:143], v[124:127]
    s_waitcnt lgkmcnt(0)
    v_mfma_f32_16x16x32_bf16 v[32:35], v[184:187], v[168:171], v[32:35]
    v_mfma_f32_16x16x32_bf16 v[36:39], v[188:191], v[168:171], v[36:39]
    v_mfma_f32_16x16x32_bf16 v[40:43], v[192:195], v[168:171], v[40:43]
    v_mfma_f32_16x16x32_bf16 v[44:47], v[196:199], v[168:171], v[44:47]
    v_mfma_f32_16x16x32_bf16 v[48:51], v[200:203], v[168:171], v[48:51]
    v_mfma_f32_16x16x32_bf16 v[52:55], v[204:207], v[168:171], v[52:55]
    v_mfma_f32_16x16x32_bf16 v[56:59], v[184:187], v[172:175], v[56:59]
    v_mfma_f32_16x16x32_bf16 v[60:63], v[188:191], v[172:175], v[60:63]
    v_mfma_f32_16x16x32_bf16 v[64:67], v[192:195], v[172:175], v[64:67]
    v_mfma_f32_16x16x32_bf16 v[68:71], v[196:199], v[172:175], v[68:71]
    v_mfma_f32_16x16x32_bf16 v[72:75], v[200:203], v[172:175], v[72:75]
    v_mfma_f32_16x16x32_bf16 v[76:79], v[204:207], v[172:175], v[76:79]
    v_mfma_f32_16x16x32_bf16 v[80:83], v[184:187], v[176:179], v[80:83]
    v_mfma_f32_16x16x32_bf16 v[84:87], v[188:191], v[176:179], v[84:87]
    v_mfma_f32_16x16x32_bf16 v[88:91], v[192:195], v[176:179], v[88:91]
    v_mfma_f32_16x16x32_bf16 v[92:95], v[196:199], v[176:179], v[92:95]
    v_mfma_f32_16x16x32_bf16 v[96:99], v[200:203], v[176:179], v[96:99]
    v_mfma_f32_16x16x32_bf16 v[100:103], v[204:207], v[176:179], v[100:103]
    v_mfma_f32_16x16x32_bf16 v[104:107], v[184:187], v[180:183], v[104:107]
    v_mfma_f32_16x16x32_bf16 v[108:111], v[188:191], v[180:183], v[108:111]
    v_mfma_f32_16x16x32_bf16 v[112:115], v[192:195], v[180:183], v[112:115]
    v_mfma_f32_16x16x32_bf16 v[116:119], v[196:199], v[180:183], v[116:119]
    v_mfma_f32_16x16x32_bf16 v[120:123], v[200:203], v[180:183], v[120:123]
    v_mfma_f32_16x16x32_bf16 v[124:127], v[204:207], v[180:183], v[124:127]
    s_waitcnt vmcnt(10)
    s_barrier
    ds_read_b128 v[128:131], v22 offset:0
    ds_read_b128 v[132:135], v22 offset:2048
    ds_read_b128 v[136:139], v22 offset:4096
    ds_read_b128 v[140:143], v22 offset:6144
    ds_read_b64_tr_b16 v[144:145], v24 offset:0
    ds_read_b64_tr_b16 v[146:147], v24 offset:512
    ds_read_b64_tr_b16 v[148:149], v25 offset:0
    ds_read_b64_tr_b16 v[150:151], v25 offset:512
    ds_read_b64_tr_b16 v[152:153], v26 offset:0
    ds_read_b64_tr_b16 v[154:155], v26 offset:512
    ds_read_b64_tr_b16 v[156:157], v27 offset:0
    ds_read_b64_tr_b16 v[158:159], v27 offset:512
    ds_read_b64_tr_b16 v[160:161], v28 offset:0
    ds_read_b64_tr_b16 v[162:163], v28 offset:512
    ds_read_b64_tr_b16 v[164:165], v29 offset:0
    ds_read_b64_tr_b16 v[166:167], v29 offset:512
    ds_read_b128 v[168:171], v23 offset:0
    ds_read_b128 v[172:175], v23 offset:2048
    ds_read_b128 v[176:179], v23 offset:4096
    ds_read_b128 v[180:183], v23 offset:6144
    ds_read_b64_tr_b16 v[184:185], v24 offset:4096
    ds_read_b64_tr_b16 v[186:187], v24 offset:4608
    ds_read_b64_tr_b16 v[188:189], v25 offset:4096
    ds_read_b64_tr_b16 v[190:191], v25 offset:4608
    ds_read_b64_tr_b16 v[192:193], v26 offset:4096
    ds_read_b64_tr_b16 v[194:195], v26 offset:4608
    ds_read_b64_tr_b16 v[196:197], v27 offset:4096
    ds_read_b64_tr_b16 v[198:199], v27 offset:4608
    ds_read_b64_tr_b16 v[200:201], v28 offset:4096
    ds_read_b64_tr_b16 v[202:203], v28 offset:4608
    ds_read_b64_tr_b16 v[204:205], v29 offset:4096
    ds_read_b64_tr_b16 v[206:207], v29 offset:4608
    s_waitcnt lgkmcnt(15)
    v_mfma_f32_16x16x32_bf16 v[32:35], v[144:147], v[128:131], v[32:35]
    v_mfma_f32_16x16x32_bf16 v[36:39], v[148:151], v[128:131], v[36:39]
    v_mfma_f32_16x16x32_bf16 v[40:43], v[152:155], v[128:131], v[40:43]
    v_mfma_f32_16x16x32_bf16 v[44:47], v[156:159], v[128:131], v[44:47]
    v_mfma_f32_16x16x32_bf16 v[48:51], v[160:163], v[128:131], v[48:51]
    v_mfma_f32_16x16x32_bf16 v[52:55], v[164:167], v[128:131], v[52:55]
    v_mfma_f32_16x16x32_bf16 v[56:59], v[144:147], v[132:135], v[56:59]
    v_mfma_f32_16x16x32_bf16 v[60:63], v[148:151], v[132:135], v[60:63]
    v_mfma_f32_16x16x32_bf16 v[64:67], v[152:155], v[132:135], v[64:67]
    v_mfma_f32_16x16x32_bf16 v[68:71], v[156:159], v[132:135], v[68:71]
    v_mfma_f32_16x16x32_bf16 v[72:75], v[160:163], v[132:135], v[72:75]
    v_mfma_f32_16x16x32_bf16 v[76:79], v[164:167], v[132:135], v[76:79]
    v_mfma_f32_16x16x32_bf16 v[80:83], v[144:147], v[136:139], v[80:83]
    v_mfma_f32_16x16x32_bf16 v[84:87], v[148:151], v[136:139], v[84:87]
    v_mfma_f32_16x16x32_bf16 v[88:91], v[152:155], v[136:139], v[88:91]
    v_mfma_f32_16x16x32_bf16 v[92:95], v[156:159], v[136:139], v[92:95]
    v_mfma_f32_16x16x32_bf16 v[96:99], v[160:163], v[136:139], v[96:99]
    v_mfma_f32_16x16x32_bf16 v[100:103], v[164:167], v[136:139], v[100:103]
    v_mfma_f32_16x16x32_bf16 v[104:107], v[144:147], v[140:143], v[104:107]
    v_mfma_f32_16x16x32_bf16 v[108:111], v[148:151], v[140:143], v[108:111]
    v_mfma_f32_16x16x32_bf16 v[112:115], v[152:155], v[140:143], v[112:115]
    v_mfma_f32_16x16x32_bf16 v[116:119], v[156:159], v[140:143], v[116:119]
    v_mfma_f32_16x16x32_bf16 v[120:123], v[160:163], v[140:143], v[120:123]
    v_mfma_f32_16x16x32_bf16 v[124:127], v[164:167], v[140:143], v[124:127]
    s_waitcnt lgkmcnt(0)
    v_mfma_f32_16x16x32_bf16 v[32:35], v[184:187], v[168:171], v[32:35]
    v_mfma_f32_16x16x32_bf16 v[36:39], v[188:191], v[168:171], v[36:39]
    v_mfma_f32_16x16x32_bf16 v[40:43], v[192:195], v[168:171], v[40:43]
    v_mfma_f32_16x16x32_bf16 v[44:47], v[196:199], v[168:171], v[44:47]
    v_mfma_f32_16x16x32_bf16 v[48:51], v[200:203], v[168:171], v[48:51]
    v_mfma_f32_16x16x32_bf16 v[52:55], v[204:207], v[168:171], v[52:55]
    v_mfma_f32_16x16x32_bf16 v[56:59], v[184:187], v[172:175], v[56:59]
    v_mfma_f32_16x16x32_bf16 v[60:63], v[188:191], v[172:175], v[60:63]
    v_mfma_f32_16x16x32_bf16 v[64:67], v[192:195], v[172:175], v[64:67]
    v_mfma_f32_16x16x32_bf16 v[68:71], v[196:199], v[172:175], v[68:71]
    v_mfma_f32_16x16x32_bf16 v[72:75], v[200:203], v[172:175], v[72:75]
    v_mfma_f32_16x16x32_bf16 v[76:79], v[204:207], v[172:175], v[76:79]
    v_mfma_f32_16x16x32_bf16 v[80:83], v[184:187], v[176:179], v[80:83]
    v_mfma_f32_16x16x32_bf16 v[84:87], v[188:191], v[176:179], v[84:87]
    v_mfma_f32_16x16x32_bf16 v[88:91], v[192:195], v[176:179], v[88:91]
    v_mfma_f32_16x16x32_bf16 v[92:95], v[196:199], v[176:179], v[92:95]
    v_mfma_f32_16x16x32_bf16 v[96:99], v[200:203], v[176:179], v[96:99]
    v_mfma_f32_16x16x32_bf16 v[100:103], v[204:207], v[176:179], v[100:103]
    v_mfma_f32_16x16x32_bf16 v[104:107], v[184:187], v[180:183], v[104:107]
    v_mfma_f32_16x16x32_bf16 v[108:111], v[188:191], v[180:183], v[108:111]
    v_mfma_f32_16x16x32_bf16 v[112:115], v[192:195], v[180:183], v[112:115]
    v_mfma_f32_16x16x32_bf16 v[116:119], v[196:199], v[180:183], v[116:119]
    v_mfma_f32_16x16x32_bf16 v[120:123], v[200:203], v[180:183], v[120:123]
    v_mfma_f32_16x16x32_bf16 v[124:127], v[204:207], v[180:183], v[124:127]
    s_waitcnt vmcnt(0)
    s_barrier
    ds_read_b128 v[128:131], v22 offset:40960
    ds_read_b128 v[132:135], v22 offset:43008
    ds_read_b128 v[136:139], v22 offset:45056
    ds_read_b128 v[140:143], v22 offset:47104
    ds_read_b64_tr_b16 v[144:145], v24 offset:40960
    ds_read_b64_tr_b16 v[146:147], v24 offset:41472
    ds_read_b64_tr_b16 v[148:149], v25 offset:40960
    ds_read_b64_tr_b16 v[150:151], v25 offset:41472
    ds_read_b64_tr_b16 v[152:153], v26 offset:40960
    ds_read_b64_tr_b16 v[154:155], v26 offset:41472
    ds_read_b64_tr_b16 v[156:157], v27 offset:40960
    ds_read_b64_tr_b16 v[158:159], v27 offset:41472
    ds_read_b64_tr_b16 v[160:161], v28 offset:40960
    ds_read_b64_tr_b16 v[162:163], v28 offset:41472
    ds_read_b64_tr_b16 v[164:165], v29 offset:40960
    ds_read_b64_tr_b16 v[166:167], v29 offset:41472
    ds_read_b128 v[168:171], v23 offset:40960
    ds_read_b128 v[172:175], v23 offset:43008
    ds_read_b128 v[176:179], v23 offset:45056
    ds_read_b128 v[180:183], v23 offset:47104
    ds_read_b64_tr_b16 v[184:185], v24 offset:45056
    ds_read_b64_tr_b16 v[186:187], v24 offset:45568
    ds_read_b64_tr_b16 v[188:189], v25 offset:45056
    ds_read_b64_tr_b16 v[190:191], v25 offset:45568
    ds_read_b64_tr_b16 v[192:193], v26 offset:45056
    ds_read_b64_tr_b16 v[194:195], v26 offset:45568
    ds_read_b64_tr_b16 v[196:197], v27 offset:45056
    ds_read_b64_tr_b16 v[198:199], v27 offset:45568
    ds_read_b64_tr_b16 v[200:201], v28 offset:45056
    ds_read_b64_tr_b16 v[202:203], v28 offset:45568
    ds_read_b64_tr_b16 v[204:205], v29 offset:45056
    ds_read_b64_tr_b16 v[206:207], v29 offset:45568
    s_waitcnt lgkmcnt(15)
    v_mfma_f32_16x16x32_bf16 v[32:35], v[144:147], v[128:131], v[32:35]
    v_mfma_f32_16x16x32_bf16 v[36:39], v[148:151], v[128:131], v[36:39]
    v_mfma_f32_16x16x32_bf16 v[40:43], v[152:155], v[128:131], v[40:43]
    v_mfma_f32_16x16x32_bf16 v[44:47], v[156:159], v[128:131], v[44:47]
    v_mfma_f32_16x16x32_bf16 v[48:51], v[160:163], v[128:131], v[48:51]
    v_mfma_f32_16x16x32_bf16 v[52:55], v[164:167], v[128:131], v[52:55]
    v_mfma_f32_16x16x32_bf16 v[56:59], v[144:147], v[132:135], v[56:59]
    v_mfma_f32_16x16x32_bf16 v[60:63], v[148:151], v[132:135], v[60:63]
    v_mfma_f32_16x16x32_bf16 v[64:67], v[152:155], v[132:135], v[64:67]
    v_mfma_f32_16x16x32_bf16 v[68:71], v[156:159], v[132:135], v[68:71]
    v_mfma_f32_16x16x32_bf16 v[72:75], v[160:163], v[132:135], v[72:75]
    v_mfma_f32_16x16x32_bf16 v[76:79], v[164:167], v[132:135], v[76:79]
    v_mfma_f32_16x16x32_bf16 v[80:83], v[144:147], v[136:139], v[80:83]
    v_mfma_f32_16x16x32_bf16 v[84:87], v[148:151], v[136:139], v[84:87]
    v_mfma_f32_16x16x32_bf16 v[88:91], v[152:155], v[136:139], v[88:91]
    v_mfma_f32_16x16x32_bf16 v[92:95], v[156:159], v[136:139], v[92:95]
    v_mfma_f32_16x16x32_bf16 v[96:99], v[160:163], v[136:139], v[96:99]
    v_mfma_f32_16x16x32_bf16 v[100:103], v[164:167], v[136:139], v[100:103]
    v_mfma_f32_16x16x32_bf16 v[104:107], v[144:147], v[140:143], v[104:107]
    v_mfma_f32_16x16x32_bf16 v[108:111], v[148:151], v[140:143], v[108:111]
    v_mfma_f32_16x16x32_bf16 v[112:115], v[152:155], v[140:143], v[112:115]
    v_mfma_f32_16x16x32_bf16 v[116:119], v[156:159], v[140:143], v[116:119]
    v_mfma_f32_16x16x32_bf16 v[120:123], v[160:163], v[140:143], v[120:123]
    v_mfma_f32_16x16x32_bf16 v[124:127], v[164:167], v[140:143], v[124:127]
    s_waitcnt lgkmcnt(0)
    v_mfma_f32_16x16x32_bf16 v[32:35], v[184:187], v[168:171], v[32:35]
    v_mfma_f32_16x16x32_bf16 v[36:39], v[188:191], v[168:171], v[36:39]
    v_mfma_f32_16x16x32_bf16 v[40:43], v[192:195], v[168:171], v[40:43]
    v_mfma_f32_16x16x32_bf16 v[44:47], v[196:199], v[168:171], v[44:47]
    v_mfma_f32_16x16x32_bf16 v[48:51], v[200:203], v[168:171], v[48:51]
    v_mfma_f32_16x16x32_bf16 v[52:55], v[204:207], v[168:171], v[52:55]
    v_mfma_f32_16x16x32_bf16 v[56:59], v[184:187], v[172:175], v[56:59]
    v_mfma_f32_16x16x32_bf16 v[60:63], v[188:191], v[172:175], v[60:63]
    v_mfma_f32_16x16x32_bf16 v[64:67], v[192:195], v[172:175], v[64:67]
    v_mfma_f32_16x16x32_bf16 v[68:71], v[196:199], v[172:175], v[68:71]
    v_mfma_f32_16x16x32_bf16 v[72:75], v[200:203], v[172:175], v[72:75]
    v_mfma_f32_16x16x32_bf16 v[76:79], v[204:207], v[172:175], v[76:79]
    v_mfma_f32_16x16x32_bf16 v[80:83], v[184:187], v[176:179], v[80:83]
    v_mfma_f32_16x16x32_bf16 v[84:87], v[188:191], v[176:179], v[84:87]
    v_mfma_f32_16x16x32_bf16 v[88:91], v[192:195], v[176:179], v[88:91]
    v_mfma_f32_16x16x32_bf16 v[92:95], v[196:199], v[176:179], v[92:95]
    v_mfma_f32_16x16x32_bf16 v[96:99], v[200:203], v[176:179], v[96:99]
    v_mfma_f32_16x16x32_bf16 v[100:103], v[204:207], v[176:179], v[100:103]
    v_mfma_f32_16x16x32_bf16 v[104:107], v[184:187], v[180:183], v[104:107]
    v_mfma_f32_16x16x32_bf16 v[108:111], v[188:191], v[180:183], v[108:111]
    v_mfma_f32_16x16x32_bf16 v[112:115], v[192:195], v[180:183], v[112:115]
    v_mfma_f32_16x16x32_bf16 v[116:119], v[196:199], v[180:183], v[116:119]
    v_mfma_f32_16x16x32_bf16 v[120:123], v[200:203], v[180:183], v[120:123]
    v_mfma_f32_16x16x32_bf16 v[124:127], v[204:207], v[180:183], v[124:127]
    s_nop 7
    s_nop 7
k2_store:
    s_mul_i32 s38, s48, 8388608
    s_add_u32 s6, s4, s38
    s_addc_u32 s7, s5, 0
    s_add_u32 s16, s6, 0x2800000
    s_addc_u32 s17, s7, 0
    s_and_b32 s17, s17, 0xffff
    s_mov_b32 s18, 0x480000
    s_mov_b32 s19, 0x00020000
    v_and_b32 v1, 15, v10
    s_lshr_b32 s39, s32, 1
    s_lshl_b32 s39, s39, 6
    s_add_u32 s39, s39, s36
    v_add_u32 v1, s39, v1
    s_movk_i32 s39, 2304
    v_mul_lo_u32 v1, s39, v1
    v_lshrrev_b32 v2, 4, v10
    v_lshlrev_b32 v2, 4, v2
    s_and_b32 s38, s32, 1
    s_mul_i32 s38, s38, 96
    s_add_u32 s38, s38, s37
    s_lshl_b32 s38, s38, 2
    v_add3_u32 v1, v1, v2, s38
    s_mov_b32 s34, 0
    buffer_store_dwordx4 v[32:35], v1, s[16:19], s34 offen
    s_mov_b32 s34, 64
    buffer_store_dwordx4 v[36:39], v1, s[16:19], s34 offen
    s_mov_b32 s34, 128
    buffer_store_dwordx4 v[40:43], v1, s[16:19], s34 offen
    s_mov_b32 s34, 192
    buffer_store_dwordx4 v[44:47], v1, s[16:19], s34 offen
    s_mov_b32 s34, 256
    buffer_store_dwordx4 v[48:51], v1, s[16:19], s34 offen
    s_mov_b32 s34, 320
    buffer_store_dwordx4 v[52:55], v1, s[16:19], s34 offen
    s_mov_b32 s34, 36864
    buffer_store_dwordx4 v[56:59], v1, s[16:19], s34 offen
    s_mov_b32 s34, 36928
    buffer_store_dwordx4 v[60:63], v1, s[16:19], s34 offen
    s_mov_b32 s34, 36992
    buffer_store_dwordx4 v[64:67], v1, s[16:19], s34 offen
    s_mov_b32 s34, 37056
    buffer_store_dwordx4 v[68:71], v1, s[16:19], s34 offen
    s_mov_b32 s34, 37120
    buffer_store_dwordx4 v[72:75], v1, s[16:19], s34 offen
    s_mov_b32 s34, 37184
    buffer_store_dwordx4 v[76:79], v1, s[16:19], s34 offen
    s_mov_b32 s34, 73728
    buffer_store_dwordx4 v[80:83], v1, s[16:19], s34 offen
    s_mov_b32 s34, 73792
    buffer_store_dwordx4 v[84:87], v1, s[16:19], s34 offen
    s_mov_b32 s34, 73856
    buffer_store_dwordx4 v[88:91], v1, s[16:19], s34 offen
    s_mov_b32 s34, 73920
    buffer_store_dwordx4 v[92:95], v1, s[16:19], s34 offen
    s_mov_b32 s34, 73984
    buffer_store_dwordx4 v[96:99], v1, s[16:19], s34 offen
    s_mov_b32 s34, 74048
    buffer_store_dwordx4 v[100:103], v1, s[16:19], s34 offen
    s_mov_b32 s34, 110592
    buffer_store_dwordx4 v[104:107], v1, s[16:19], s34 offen
    s_mov_b32 s34, 110656
    buffer_store_dwordx4 v[108:111], v1, s[16:19], s34 offen
    s_mov_b32 s34, 110720
    buffer_store_dwordx4 v[112:115], v1, s[16:19], s34 offen
    s_mov_b32 s34, 110784
    buffer_store_dwordx4 v[116:119], v1, s[16:19], s34 offen
    s_mov_b32 s34, 110848
    buffer_store_dwordx4 v[120:123], v1, s[16:19], s34 offen
    s_mov_b32 s34, 110912
    buffer_store_dwordx4 v[124:127], v1, s[16:19], s34 offen
    s_waitcnt vmcnt(0)
k2_done:
    s_endpgm
.globl final_kernel
.p2align 8
.type final_kernel,@function
final_kernel:
    s_cmp_ge_u32 s2, 1152
    s_cbranch_scc1 k3_done
    s_load_dwordx2 s[4:5], s[0:1], 88
    s_load_dwordx2 s[6:7], s[0:1], 0
    s_load_dwordx2 s[20:21], s[0:1], 72
    s_lshl_b32 s3, s2, 8
    v_add_u32 v1, s3, v0
    v_lshlrev_b32 v2, 4, v1
    v_lshlrev_b32 v3, 3, v1
    s_waitcnt lgkmcnt(0)
    s_add_u32 s8, s4, 0x2800000
    s_addc_u32 s9, s5, 0
    s_and_b32 s9, s9, 0xffff
    s_mov_b32 s10, 0x2480000
    s_mov_b32 s11, 0x00020000
    s_mov_b32 s12, s6
    s_mov_b32 s13, s7
    s_and_b32 s13, s13, 0xffff
    s_mov_b32 s14, 0x240000
    s_mov_b32 s15, 0x00020000
    s_mov_b32 s16, s20
    s_mov_b32 s17, s21
    s_and_b32 s17, s17, 0xffff
    s_mov_b32 s18, 0x240000
    s_mov_b32 s19, 0x00020000
    s_mov_b32 s22, 0
    buffer_load_dwordx4 v[8:11], v2, s[8:11], s22 offen
    s_mov_b32 s22, 8388608
    buffer_load_dwordx4 v[12:15], v2, s[8:11], s22 offen
    s_mov_b32 s22, 16777216
    buffer_load_dwordx4 v[16:19], v2, s[8:11], s22 offen
    s_mov_b32 s22, 25165824
    buffer_load_dwordx4 v[20:23], v2, s[8:11], s22 offen
    s_mov_b32 s22, 33554432
    buffer_load_dwordx4 v[24:27], v2, s[8:11], s22 offen
    buffer_load_dwordx2 v[4:5], v3, s[12:15], 0 offen
    s_waitcnt vmcnt(0)
    v_cvt_pk_bf16_f32 v30, v8, v9
    v_cvt_pk_bf16_f32 v31, v10, v11
    v_cvt_pk_bf16_f32 v32, v12, v13
    v_cvt_pk_bf16_f32 v33, v14, v15
    v_lshlrev_b32 v34, 16, v30
    v_and_b32 v35, 0xffff0000, v30
    v_lshlrev_b32 v38, 16, v32
    v_and_b32 v39, 0xffff0000, v32
    v_lshlrev_b32 v36, 16, v31
    v_and_b32 v37, 0xffff0000, v31
    v_lshlrev_b32 v40, 16, v33
    v_and_b32 v41, 0xffff0000, v33
    v_sub_f32 v34, v34, v38
    v_sub_f32 v35, v35, v39
    v_sub_f32 v36, v36, v40
    v_sub_f32 v37, v37, v41
    v_cvt_pk_bf16_f32 v30, v34, v35
    v_cvt_pk_bf16_f32 v31, v36, v37
    v_lshlrev_b32 v34, 16, v30
    v_and_b32 v35, 0xffff0000, v30
    v_lshlrev_b32 v36, 16, v31
    v_and_b32 v37, 0xffff0000, v31
    v_add_f32 v16, v16, v20
    v_add_f32 v17, v17, v21
    v_add_f32 v18, v18, v22
    v_add_f32 v19, v19, v23
    v_add_f32 v16, v16, v24
    v_add_f32 v17, v17, v25
    v_add_f32 v18, v18, v26
    v_add_f32 v19, v19, v27
    v_cvt_pk_bf16_f32 v30, v16, v17
    v_cvt_pk_bf16_f32 v31, v18, v19
    v_lshlrev_b32 v38, 16, v30
    v_and_b32 v39, 0xffff0000, v30
    v_lshlrev_b32 v40, 16, v31
    v_and_b32 v41, 0xffff0000, v31
    v_mul_f32 v42, 0xbfb8aa3b, v38
    v_mul_f32 v43, 0xbfb8aa3b, v39
    v_mul_f32 v44, 0xbfb8aa3b, v40
    v_mul_f32 v45, 0xbfb8aa3b, v41
    v_exp_f32 v42, v42
    v_exp_f32 v43, v43
    v_exp_f32 v44, v44
    v_exp_f32 v45, v45
    v_add_f32 v42, 1.0, v42
    v_add_f32 v43, 1.0, v43
    v_add_f32 v44, 1.0, v44
    v_add_f32 v45, 1.0, v45
    v_rcp_f32 v42, v42
    v_rcp_f32 v43, v43
    v_rcp_f32 v44, v44
    v_rcp_f32 v45, v45
    s_nop 0
    v_mul_f32 v42, v42, v38
    v_mul_f32 v43, v43, v39
    v_mul_f32 v44, v44, v40
    v_mul_f32 v45, v45, v41
    v_cvt_pk_bf16_f32 v30, v42, v43
    v_cvt_pk_bf16_f32 v31, v44, v45
    v_lshlrev_b32 v42, 16, v30
    v_and_b32 v43, 0xffff0000, v30
    v_lshlrev_b32 v44, 16, v31
    v_and_b32 v45, 0xffff0000, v31
    v_mul_f32 v42, v42, v34
    v_mul_f32 v43, v43, v35
    v_mul_f32 v44, v44, v36
    v_mul_f32 v45, v45, v37
    v_cvt_pk_bf16_f32 v30, v42, v43
    v_cvt_pk_bf16_f32 v31, v44, v45
    v_lshlrev_b32 v42, 16, v30
    v_and_b32 v43, 0xffff0000, v30
    v_lshlrev_b32 v46, 16, v4
    v_and_b32 v47, 0xffff0000, v4
    v_lshlrev_b32 v44, 16, v31
    v_and_b32 v45, 0xffff0000, v31
    v_lshlrev_b32 v48, 16, v5
    v_and_b32 v49, 0xffff0000, v5
    v_add_f32 v42, v42, v46
    v_add_f32 v43, v43, v47
    v_add_f32 v44, v44, v48
    v_add_f32 v45, v45, v49
    v_cvt_pk_bf16_f32 v30, v42, v43
    v_cvt_pk_bf16_f32 v31, v44, v45
    buffer_store_dwordx2 v[30:31], v3, s[16:19], 0 offen
    s_waitcnt vmcnt(0)
k3_done:
    s_endpgm
.section .rodata,"a"
.p2align 6
.amdhsa_kernel ln_kernel
  .amdhsa_next_free_vgpr 80
  .amdhsa_next_free_sgpr 102
  .amdhsa_accum_offset 80
  .amdhsa_group_segment_fixed_size 0
  .amdhsa_kernarg_size 96
  .amdhsa_user_sgpr_count 2
  .amdhsa_user_sgpr_kernarg_segment_ptr 1
  .amdhsa_system_sgpr_workgroup_id_x 1
.end_amdhsa_kernel
.p2align 6
.amdhsa_kernel gemm1_kernel
  .amdhsa_next_free_vgpr 160
  .amdhsa_next_free_sgpr 102
  .amdhsa_accum_offset 160
  .amdhsa_group_segment_fixed_size 0
  .amdhsa_kernarg_size 96
  .amdhsa_user_sgpr_count 2
  .amdhsa_user_sgpr_kernarg_segment_ptr 1
  .amdhsa_system_sgpr_workgroup_id_x 1
.end_amdhsa_kernel
.p2align 6
.amdhsa_kernel gemm2_kernel
  .amdhsa_next_free_vgpr 208
  .amdhsa_next_free_sgpr 102
  .amdhsa_accum_offset 208
  .amdhsa_group_segment_fixed_size 0
  .amdhsa_kernarg_size 96
  .amdhsa_user_sgpr_count 2
  .amdhsa_user_sgpr_kernarg_segment_ptr 1
  .amdhsa_system_sgpr_workgroup_id_x 1
.end_amdhsa_kernel
.p2align 6
.amdhsa_kernel final_kernel
  .amdhsa_next_free_vgpr 56
  .amdhsa_next_free_sgpr 102
  .amdhsa_accum_offset 56
  .amdhsa_group_segment_fixed_size 0
  .amdhsa_kernarg_size 96
  .amdhsa_user_sgpr_count 2
  .amdhsa_user_sgpr_kernarg_segment_ptr 1
  .amdhsa_system_sgpr_workgroup_id_x 1
.end_amdhsa_kernel
```
